```python
import torch

def _softmax(x, axis=-1):
    return torch.softmax(x, dim=axis)

def _gelu(x):
    return torch.nn.functional.gelu(x, approximate='tanh')

def _silu(x):
    return torch.nn.functional.silu(x)

def _sigmoid(x):
    return torch.sigmoid(x)

def _layernorm(x, axis=-1, eps=1e-05):
    m = x.mean(dim=axis, keepdim=True)
    v = x.var(dim=axis, keepdim=True, unbiased=False)
    return (x - m) / torch.sqrt(v + eps)

def _scatter_add(tgt, idx, src, axis=0):
    return tgt.clone().index_add_(axis, idx, src)

def _segment_sum(src, seg, n):
    out = torch.zeros((n,) + src.shape[1:], dtype=src.dtype)
    return out.index_add_(0, seg, src)

def _pad(x, pw):
    flat = tuple((v for pair in reversed(pw) for v in pair))
    return torch.nn.functional.pad(x, flat)
kernel_name = 'standalone__factorization_afm__recsys'

def setup_inputs():

    _w = lambda a: (lambda t: t.to(torch.bfloat16) if t.is_floating_point() else t)(torch.as_tensor(a))
    B, F, D, V = (1024, 100, 32, min(1000000, 100000))
    A = D
    ii, jj = tuple(torch.triu_indices(F, F, 1).unbind(0))
    return {'idx': _w((lambda lo, hi, *s: torch.randint(lo, hi, s))(0, V, B, F).to(torch.int64)), 'table': _w((lambda *s: torch.randn(*s, dtype=torch.bfloat16) * 0.8)(V, D)), 'ii': _w(ii.to(torch.int64)), 'jj': _w(jj.to(torch.int64)), 'W': _w((lambda *s: torch.randn(*s, dtype=torch.bfloat16) * 0.8)(D, A) * (1.0 / D ** 0.5)), 'b': _w((lambda *s: torch.randn(*s, dtype=torch.bfloat16) * 0.8)(A)), 'h': _w((lambda *s: torch.randn(*s, dtype=torch.bfloat16) * 0.8)(A)), 'p': _w((lambda *s: torch.randn(*s, dtype=torch.bfloat16) * 0.8)(D))}

def reference(idx, table, ii, jj, W, b, h, p):
    emb = table[idx]
    ei = emb[:, ii, :].clone()
    ej = emb[:, jj, :].clone()
    pair = ei * ej
    hid = pair @ W + b
    hid = 0.5 * (hid + torch.abs(hid))
    e = hid @ h
    alpha = _softmax(e, axis=-1)
    pooled = torch.einsum('bp,bpd->bd', alpha, pair)
    return pooled @ p
```

```asm
; @launch grid=(256,1,1) block=(512,1,1) lds=94032
.amdgcn_target "amdgcn-amd-amdhsa--gfx950"
.text
.globl standalone__factorization_afm__recsys_kernel
.p2align 8
.type standalone__factorization_afm__recsys_kernel,@function
standalone__factorization_afm__recsys_kernel:
    s_cmpk_ge_u32 s2, 256
    s_cbranch_scc1 L_end
    s_load_dwordx2 s[4:5], s[0:1], 0
    s_load_dwordx2 s[36:37], s[0:1], 8
    s_load_dwordx8 s[8:15], s[0:1], 32
    s_getpc_b64 s[44:45]
L_pc:
    v_sub_u32 v6, 511, v0
    v_lshlrev_b32 v6, 7, v6
    v_cmp_gt_u32 vcc, L_end-L_pc, v6
    s_and_saveexec_b64 s[34:35], vcc
    s_cbranch_execz L_nocpf
    v_mov_b32 v7, 0
    v_lshl_add_u64 v[6:7], v[6:7], 0, s[44:45]
    global_load_dword v121, v[6:7], off
L_nocpf:
    s_mov_b64 exec, -1
    v_lshrrev_b32 v1, 6, v0
    v_and_b32 v2, 60, v0
    v_readfirstlane_b32 s20, v1
    s_and_b32 s3, s2, 7
    s_lshl_b32 s3, s3, 5
    s_lshr_b32 s47, s2, 3
    s_add_u32 s3, s3, s47
    s_lshl_b32 s3, s3, 2
    s_and_b32 s21, s20, 3
    s_lshr_b32 s22, s20, 2
    s_add_u32 s3, s3, s21
    s_mul_i32 s30, s3, 400
    s_lshl_b32 s31, s22, 7
    s_add_u32 s31, s30, s31
    s_add_u32 s47, s22, 1
    v_lshlrev_b32 v3, s47, v2
    v_add_u32 v3, s31, v3
    v_add_u32 v2, s30, v2
    v_lshlrev_b32 v4, 3, v0
    v_and_b32 v1, 56, v4
    v_lshlrev_b32 v5, 2, v0
    v_and_b32 v5, 60, v5
    s_cmp_eq_u32 s22, 0
    s_waitcnt lgkmcnt(0)
    global_load_dwordx4 v[112:115], v3, s[4:5]
    s_cbranch_scc1 L_r0g
    global_load_dwordx2 v[144:145], v4, s[8:9] offset:-2048
    global_load_dwordx2 v[146:147], v1, s[12:13]
    global_load_dword v148, v5, s[12:13]
    global_load_dword v149, v5, s[10:11]
    global_load_dword v150, v5, s[14:15]
L_r0g:
    s_mov_b32 s38, 6400000
    s_mov_b32 s39, 0x00020000
    v_and_b32 v6, 3, v0
    v_lshlrev_b32 v122, 4, v6
    s_cbranch_scc0 L_ga
    s_waitcnt vmcnt(0)
    v_lshl_or_b32 v112, v112, 6, v122
    buffer_load_dwordx4 v[56:59], v112, s[36:39], 0 offen
    v_lshl_or_b32 v113, v113, 6, v122
    buffer_load_dwordx4 v[60:63], v113, s[36:39], 0 offen
L_ga:
    s_mov_b32 s6, 409600
    s_mov_b32 s7, 0x00020000
    s_load_dwordx4 s[16:19], s[0:1], 64
    v_and_b32 v253, 63, v0
    v_bfe_u32 v141, v0, 5, 1
    s_mul_i32 s23, s21, 22656
    s_lshl_b32 s31, s21, 4
    s_add_u32 s31, s31, 93952
    v_mov_b32 v252, s31
    s_mov_b32 s43, 0xffff0000
    v_mov_b32 v240, 0
    v_mov_b32 v241, 0
    v_mov_b32 v242, 0
    v_mov_b32 v243, 0
    s_add_u32 s31, s23, 4544
    v_mov_b32 v140, s31
    v_lshrrev_b32 v7, 2, v253
    v_xor_b32 v7, v7, v253
    v_and_b32 v123, 4, v7
    v_lshrrev_b32 v6, 4, v253
    v_lshlrev_b32 v6, 5, v6
    v_and_b32 v7, 4, v253
    v_lshl_add_u32 v6, v7, 2, v6
    v_add_u32 v6, 93568, v6
    v_cmp_eq_u32 vcc, 0, v122
    v_cmp_eq_u32 s[34:35], 16, v122
    v_bfe_u32 v7, v253, 2, 3
    v_cndmask_b32 v135, v140, v6, vcc
    v_cndmask_b32 v136, v140, v6, s[34:35]
    v_and_b32 v6, 1, v253
    v_lshl_add_u32 v6, v7, 1, v6
    v_mul_u32_u24 v6, 80, v6
    v_lshl_add_u32 v6, v141, 4, v6
    v_add_u32 v134, 90624, v6
    v_lshlrev_b32 v6, 6, v141
    v_add_u32 v137, 93184, v6
    s_cmp_eq_u32 s22, 0
    s_cbranch_scc1 L_r0a
    buffer_load_dword v116, v2, s[4:7], 0 offen offset:384
    v_lshl_add_u32 v6, v253, 4, v140
    ds_write_b128 v6, v[240:243]
    ds_write_b128 v6, v[240:243] offset:11328
    v_mov_b32 v6, -1.0
    ds_write_b32 v252, v6
    ds_write_b64 v252, v[240:241] offset:8
    v_mov_b32 v133, 0x7fc07fc0
    v_mul_u32_u24 v131, 20, v1
    v_bfe_u32 v132, v0, 3, 5
    v_lshlrev_b32 v132, 1, v132
    v_add_u32 v132, 90624, v132
    v_add_u32 v131, v131, v132
    v_and_b32 v1, 16, v253
    v_sub_u32 v2, 16, v1
    v_and_b32 v3, 1, v253
    v_lshlrev_b32 v1, 3, v1
    s_cmp_eq_u32 s21, 1
    s_cbranch_scc1 L_ta_h
    v_and_b32 v6, 12, v253
    v_add_u32 v3, v3, v6
    v_lshl_add_u32 v3, v141, 1, v3
    v_and_b32 v6, 2, v253
    v_lshlrev_b32 v6, 5, v6
    v_lshl_add_u32 v3, v3, 2, v6
    v_add_u32 v3, 93184, v3
    v_add_u32 v1, v1, v3
    s_branch L_ta_d
L_ta_h:
    v_lshlrev_b32 v6, 2, v253
    v_add_u32 v6, 93568, v6
    ds_write_b32 v6, v240
    v_lshl_add_u32 v1, v3, 1, v1
    v_and_b32 v6, 4, v253
    v_add_u32 v1, v1, v6
    v_and_b32 v6, 2, v253
    v_lshl_add_u32 v1, v6, 4, v1
    v_and_b32 v6, 8, v253
    v_lshl_add_u32 v1, v6, 3, v1
    v_mad_u32_u24 v1, v141, 24, v1
    v_add_u32 v1, 93568, v1
L_ta_d:
    s_waitcnt vmcnt(1)
    v_dot2_f32_bf16 v126, v144, v146, 0
    v_lshlrev_b32 v127, 16, v144
    v_and_b32 v128, s43, v144
    v_dot2_f32_bf16 v126, v145, v147, v126
    v_lshlrev_b32 v129, 16, v145
    v_and_b32 v130, s43, v145
    v_mul_f32 v127, 0x41b8aa3b, v127
    v_mul_f32 v128, 0x41b8aa3b, v128
    v_add_f32_dpp v126, v126, v126 row_shr:1 row_mask:0xf bank_mask:0xf
    v_mul_f32 v129, 0x41b8aa3b, v129
    v_mul_f32 v130, 0x41b8aa3b, v130
    v_add_f32_dpp v126, v126, v126 row_shr:2 row_mask:0xf bank_mask:0xf
    v_max3_f32 v6, |v127|, |v128|, |v129|
    v_max_f32 v6, |v130|, v6
    v_add_f32_dpp v126, v126, v126 row_shr:4 row_mask:0xf bank_mask:0xf
    v_cmp_nge_f32 vcc, 0x42000000, v6
    v_cvt_pk_f16_f32 v127, v127, v128
    v_cvt_pk_f16_f32 v129, v129, v130
    v_mul_f32 v126, 0x3f38aa3b, v126
    v_cndmask_b32 v127, v127, v133, vcc
    ds_write_b16 v131, v129 offset:80
    ds_write_b16_d16_hi v131, v129 offset:1360
    v_and_b32 v6, 0x7fffffff, v126
    v_cmp_nge_f32 vcc, 0x42800000, v6
    ds_write_b16 v131, v127
    ds_write_b16_d16_hi v131, v127 offset:1280
    v_cvt_f16_f32 v126, v126
    s_mov_b32 exec_lo, 0x80808080
    s_mov_b32 exec_hi, 0x80808080
    v_cndmask_b32 v126, v126, v133, vcc
    ds_write_b16 v132, v126 offset:3200
    s_mov_b64 exec, -1
    s_cbranch_scc1 L_sq_h
    s_cmp_eq_u32 s21, 2
    s_cbranch_scc1 L_sq_p
    s_cmp_eq_u32 s21, 3
    s_cbranch_scc1 L_bar1
    v_lshlrev_b32 v6, v2, v149
    v_and_b32 v6, s43, v6
    v_mul_f32 v6, 0x41b8aa3b, v6
    ds_write_b32 v1, v6
    s_mov_b32 exec_lo, 0xffff
    s_mov_b32 exec_hi, 0xffff0000
    ds_write_b32 v3, v6 offset:256
    s_mov_b64 exec, -1
    s_branch L_bar1
L_sq_h:
    v_lshlrev_b32 v6, v2, v148
    v_and_b32 v6, s43, v6
    v_and_b32 v7, 0x7fffffff, v6
    v_cmp_nge_f32 vcc, 0x41000000, v7
    v_mul_f32 v6, 0x3d000000, v6
    s_nop 0
    v_cndmask_b32 v6, v6, v133, vcc
    ds_write_b16_d16_hi v1, v6
    s_branch L_bar1
L_sq_p:
    v_lshlrev_b32 v6, 16, v150
    v_and_b32 v7, s43, v150
    v_max_f32 v1, |v6|, |v7|
    v_cmp_le_f32 vcc, 0x3e000000, v1
    v_cvt_pk_f16_f32 v6, v6, v7
    v_add_u32 v5, 93888, v5
    s_cmp_eq_u64 vcc, 0
    s_cselect_b32 s47, -1.0, 0x45000000
    v_cmp_nge_f32 vcc, s47, v1
    s_nop 1
    v_cndmask_b32 v6, v6, v133, vcc
    ds_write_b32 v5, v6
    s_branch L_bar1
L_r0a:
    v_and_b32 v6, 11, v253
    v_or_b32 v6, v6, v123
    v_lshlrev_b32 v7, 4, v141
    v_add_u32 v7, 93824, v7
    v_add_u32 v124, 64, v7
    v_cmp_eq_u32 vcc, 0, v6
    v_cmp_eq_u32 s[34:35], 2, v6
    s_nop 0
    v_cndmask_b32 v138, v140, v7, vcc
    v_cndmask_b32 v138, v138, v124, s[34:35]
    v_cmp_eq_u32 vcc, 9, v6
    v_cmp_eq_u32 s[34:35], 10, v6
    s_nop 0
    v_cndmask_b32 v139, v140, v7, vcc
    v_cndmask_b32 v139, v139, v124, s[34:35]
    v_bfe_u32 v6, v253, 1, 1
    v_mul_u32_u24 v6, 1280, v6
    v_and_b32 v7, 8, v253
    v_lshlrev_b32 v7, 4, v7
    v_add_u32 v126, v134, v6
    v_add_u32 v127, v135, v7
    v_add_u32 v128, v136, v7
L_bar1:
    s_waitcnt lgkmcnt(0)
    s_barrier
    s_cmp_lg_u32 s22, 0
    s_cbranch_scc1 L_role1
L_role0:
    v_mov_b32 v188, 0xff800000
    v_mov_b32 v189, 0xff800000
    v_mov_b32 v190, 0
    ds_read_b128 v[200:203], v126 offset:0
    ds_read_b128 v[204:207], v126 offset:32
    ds_read_b128 v[208:211], v137 offset:256
    ds_read_b128 v[212:215], v137 offset:272
    ds_read_b128 v[216:219], v137 offset:288
    ds_read_b128 v[220:223], v137 offset:304
    ds_read_b128 v[224:227], v127 offset:0
    ds_read_b128 v[228:231], v128 offset:0
    ds_read_b128 v[176:179], v138 offset:0
    ds_read_b128 v[180:183], v138 offset:32
    ds_read_b128 v[232:235], v139 offset:0
    ds_read_b128 v[236:239], v139 offset:32
    v_mov_b32 v254, 0
    s_movk_i32 s46, 148
    v_mul_u32_u24 v6, 354, v122
    v_lshrrev_b32 v7, 2, v253
    v_lshl_add_u32 v6, v7, 4, v6
    s_mul_i32 s31, s22, 768
    s_add_u32 s31, s31, s23
    v_add_u32 v255, s31, v6
    s_mul_i32 s30, s22, 576
    s_add_u32 s30, s30, s23
    s_sub_u32 s30, s30, 64
    v_mul_u32_u24 v142, 5664, v141
    v_and_b32 v143, 31, v253
    v_lshl_add_u32 v6, v143, 4, v142
    v_add_u32 v251, s23, v6
    v_add_u32 v6, 832, v6
    v_add_u32 v246, s30, v6
    v_bfe_u32 v6, v253, 1, 1
    v_lshl_add_u32 v7, v6, 4, v142
    v_add_u32 v7, 768, v7
    v_add_u32 v247, s30, v7
    v_mul_u32_u24 v6, 68, v6
    v_and_b32 v7, 1, v253
    v_lshl_add_u32 v6, v7, 1, v6
    v_bfe_u32 v7, v253, 3, 1
    v_add_u32 v6, s46, v6
    v_lshl_add_u32 v6, v6, 4, v142
    v_cmp_eq_u32 vcc, 0, v123
    v_add_u32 v249, s30, v6
    v_lshl_add_u32 v6, v7, 4, v249
    v_mul_u32_u24 v7, 0xaaaa, v7
    v_add_u32 v250, 0x4444, v7
    v_cndmask_b32 v248, v140, v6, vcc
    v_and_b32 v6, 4, v253
    v_lshl_add_u32 v249, v6, 2, v249
    v_and_b32 v6, 24, v253
    v_lshl_add_u32 v249, v6, 3, v249
    s_add_u32 s31, s23, 768
    v_lshl_add_u32 v6, v5, 4, v142
    v_add_u32 v6, s31, v6
    v_and_b32 v7, 16, v253
    v_add_u32 v2, v6, v7
    v_add_u32 v1, v2, v7
    v_sub_u32 v3, v6, v7
    v_lshrrev_b32 v6, 1, v5
    v_mov_b32 v7, 0x940
    v_bfe_u32 v4, v7, v6, 2
    v_mov_b32 v7, 0xfb9
    v_bfe_u32 v5, v7, v6, 2
    v_add_u32 v6, 1024, v142
    v_add_u32 v6, s31, v6
    v_lshl_add_u32 v4, v4, 4, v6
    v_lshl_add_u32 v5, v5, 4, v6
    v_cmp_gt_u32 vcc, 16, v143
    v_add_u32 v6, 256, v251
    s_nop 0
    v_cndmask_b32 v4, v4, v251, vcc
    v_cndmask_b32 v5, v5, v6, vcc
    ds_read_b128 v[8:11], v134 offset:0
    ds_read_b128 v[12:15], v134 offset:32
    ds_read_b128 v[16:19], v134 offset:1280
    ds_read_b128 v[20:23], v134 offset:1312
    ds_read_b128 v[24:27], v137 offset:0
    ds_read_b128 v[28:31], v137 offset:16
    ds_read_b128 v[32:35], v137 offset:32
    ds_read_b128 v[36:39], v137 offset:48
    ds_read_b128 v[40:43], v137 offset:128
    ds_read_b128 v[44:47], v137 offset:144
    ds_read_b128 v[48:51], v137 offset:160
    ds_read_b128 v[52:55], v137 offset:176
    ds_read_b128 v[160:163], v135 offset:0
    ds_read_b128 v[168:171], v136 offset:0
    ds_read_b128 v[164:167], v135 offset:128
    ds_read_b128 v[172:175], v136 offset:128
    s_waitcnt vmcnt(1)
    v_lshlrev_b32 v6, 16, v56
    v_and_b32 v7, s43, v56
    v_cvt_pk_f16_f32 v56, v6, v7
    v_lshlrev_b32 v6, 16, v57
    v_and_b32 v7, s43, v57
    v_cvt_pk_f16_f32 v57, v6, v7
    v_lshlrev_b32 v6, 16, v58
    v_and_b32 v7, s43, v58
    v_cvt_pk_f16_f32 v58, v6, v7
    v_lshlrev_b32 v6, 16, v59
    v_and_b32 v7, s43, v59
    v_cvt_pk_f16_f32 v59, v6, v7
    ds_write_b128 v255, v[56:59] offset:0
    ds_write_b128 v255, v[56:59] offset:512
    v_pk_maximum3_f16 v254, v56, v56, v254 neg_lo:[0,1,0] neg_hi:[0,1,0]
    v_pk_maximum3_f16 v254, v57, v57, v254 neg_lo:[0,1,0] neg_hi:[0,1,0]
    v_pk_maximum3_f16 v254, v58, v58, v254 neg_lo:[0,1,0] neg_hi:[0,1,0]
    v_pk_maximum3_f16 v254, v59, v59, v254 neg_lo:[0,1,0] neg_hi:[0,1,0]
    s_waitcnt vmcnt(0)
    v_lshlrev_b32 v6, 16, v60
    v_and_b32 v7, s43, v60
    v_cvt_pk_f16_f32 v60, v6, v7
    v_lshlrev_b32 v6, 16, v61
    v_and_b32 v7, s43, v61
    v_cvt_pk_f16_f32 v61, v6, v7
    v_lshlrev_b32 v6, 16, v62
    v_and_b32 v7, s43, v62
    v_cvt_pk_f16_f32 v62, v6, v7
    v_lshlrev_b32 v6, 16, v63
    v_and_b32 v7, s43, v63
    v_cvt_pk_f16_f32 v63, v6, v7
    ds_write_b128 v255, v[60:63] offset:256
    ds_write_b32 v252, v252 offset:8
    ds_read_b128 v[104:107], v251 offset:0
    ds_read_b128 v[108:111], v251 offset:11328
    ds_read_b128 v[72:75], v251 offset:16
    ds_read_b128 v[76:79], v251 offset:11344
    ds_read_b128 v[80:83], v251 offset:32
    ds_read_b128 v[84:87], v251 offset:11360
    ds_read_b128 v[88:91], v251 offset:48
    ds_read_b128 v[92:95], v251 offset:11376
    ds_read_b128 v[96:99], v251 offset:64
    ds_read_b128 v[100:103], v251 offset:11392
    v_pk_maximum3_f16 v254, v60, v60, v254 neg_lo:[0,1,0] neg_hi:[0,1,0]
    v_pk_maximum3_f16 v254, v61, v61, v254 neg_lo:[0,1,0] neg_hi:[0,1,0]
    v_pk_maximum3_f16 v254, v62, v62, v254 neg_lo:[0,1,0] neg_hi:[0,1,0]
    v_pk_maximum3_f16 v254, v63, v63, v254 neg_lo:[0,1,0] neg_hi:[0,1,0]
    v_lshrrev_b32 v6, 16, v254
    v_and_b32 v7, 0xffff, v254
    v_max_u32 v6, v6, v7
    v_cmp_le_u32 vcc, 0x3000, v6
    v_mov_b32 v7, 0x7fc00000
    s_nop 0
    s_cmp_eq_u64 vcc, 0
    s_cselect_b32 s47, -1, 0x4800
    v_cmp_lt_i32 vcc, s47, v6
    s_nop 1
    v_cndmask_b32 v240, v240, v7, vcc
    s_mov_b32 s24, 3
    s_waitcnt lgkmcnt(6)
    v_pk_mul_f16 v56, v104, v72
    v_pk_mul_f16 v57, v105, v73
    v_pk_mul_f16 v58, v106, v74
    v_pk_mul_f16 v59, v107, v75
    v_pk_mul_f16 v60, v108, v76
    v_pk_mul_f16 v61, v109, v77
    v_pk_mul_f16 v62, v110, v78
    v_pk_mul_f16 v63, v111, v79
    v_mfma_f32_32x32x16_f16 v[128:143], v[200:203], v[56:59], v[208:223]
    s_waitcnt lgkmcnt(4)
    v_pk_mul_f16 v64, v104, v80
    v_pk_mul_f16 v65, v105, v81
    v_pk_mul_f16 v66, v106, v82
    v_pk_mul_f16 v67, v107, v83
    v_pk_mul_f16 v68, v108, v84
    v_pk_mul_f16 v69, v109, v85
    ds_read_b128 v[72:75], v251 offset:80
    ds_read_b128 v[76:79], v251 offset:11408
    v_mfma_f32_32x32x16_f16 v[128:143], v[204:207], v[60:63], v[128:143]
    v_pk_mul_f16 v70, v110, v86
    v_pk_mul_f16 v71, v111, v87
    v_mfma_f32_16x16x32_f16 v[184:187], v[176:179], v[56:59], 0
    v_mfma_f32_16x16x32_f16 v[184:187], v[180:183], v[60:63], v[184:187]
    v_mfma_f32_32x32x16_f16 v[112:127], v[200:203], v[64:67], v[208:223]
    s_waitcnt lgkmcnt(4)
    v_pk_mul_f16 v56, v104, v88
    v_pk_mul_f16 v57, v105, v89
    v_pk_mul_f16 v58, v106, v90
    v_pk_mul_f16 v59, v107, v91
    v_pk_mul_f16 v60, v108, v92
    s_nop 0
    v_cvt_pk_bf16_f32 v152, |v128|, |v129|
    ds_read_b128 v[80:83], v251 offset:96
    ds_read_b128 v[84:87], v251 offset:11424
    v_mfma_f32_32x32x16_f16 v[112:127], v[204:207], v[68:71], v[112:127]
    v_cvt_pk_bf16_f32 v153, |v130|, |v131|
    v_cvt_pk_bf16_f32 v154, |v132|, |v133|
    v_cvt_pk_bf16_f32 v155, |v134|, |v135|
    v_cvt_pk_bf16_f32 v156, |v136|, |v137|
    v_cvt_pk_bf16_f32 v157, |v138|, |v139|
    v_cvt_pk_bf16_f32 v158, |v140|, |v141|
    v_mfma_f32_16x16x32_f16 v[184:187], v[232:235], v[64:67], v[184:187]
    v_cvt_pk_bf16_f32 v159, |v142|, |v143|
    v_pk_mul_f16 v61, v109, v93
    v_mfma_f32_16x16x32_f16 v[184:187], v[236:239], v[68:71], v[184:187]
    v_pk_mul_f16 v62, v110, v94
    v_pk_mul_f16 v63, v111, v95
L_qloop:
    v_mfma_f32_32x32x16_f16 v[128:143], v[200:203], v[56:59], v[208:223]
    s_waitcnt lgkmcnt(4)
    v_pk_mul_f16 v64, v104, v96
    v_pk_mul_f16 v65, v105, v97
    v_pk_mul_f16 v66, v106, v98
    v_pk_mul_f16 v67, v107, v99
    v_pk_mul_f16 v68, v108, v100
    v_pk_mul_f16 v69, v109, v101
    ds_read_b128 v[88:91], v251 offset:112
    ds_read_b128 v[92:95], v251 offset:11440
    v_mfma_f32_32x32x16_f16 v[128:143], v[204:207], v[60:63], v[128:143]
    v_permlane32_swap_b32 v188, v189
    v_add_f32 v188, v188, v189
    v_exp_f32 v242, v188
    v_cvt_pk_bf16_f32 v144, |v112|, |v113|
    v_smfmac_f32_16x16x64_bf16 v[184:187], v[224:227], v[152:159], v250
    v_add_f32 v240, v240, v242
    v_fmac_f32 v241, v242, v190
    v_mfma_f32_16x16x32_f16 v[188:191], v[176:179], v[56:59], 0
    v_cvt_pk_bf16_f32 v145, |v114|, |v115|
    v_cvt_pk_bf16_f32 v146, |v116|, |v117|
    v_mfma_f32_16x16x32_f16 v[188:191], v[180:183], v[60:63], v[188:191]
    v_cvt_pk_bf16_f32 v147, |v118|, |v119|
    v_cvt_pk_bf16_f32 v148, |v120|, |v121|
    v_cvt_pk_bf16_f32 v149, |v122|, |v123|
    v_cvt_pk_bf16_f32 v150, |v124|, |v125|
    v_cvt_pk_bf16_f32 v151, |v126|, |v127|
    v_pk_mul_f16 v70, v110, v102
    v_pk_mul_f16 v71, v111, v103
    v_mfma_f32_32x32x16_f16 v[112:127], v[200:203], v[64:67], v[208:223]
    s_waitcnt lgkmcnt(4)
    v_pk_mul_f16 v56, v104, v72
    v_pk_mul_f16 v57, v105, v73
    v_pk_mul_f16 v58, v106, v74
    v_pk_mul_f16 v59, v107, v75
    v_pk_mul_f16 v60, v108, v76
    v_cvt_pk_bf16_f32 v152, |v128|, |v129|
    ds_read_b128 v[96:99], v251 offset:128
    ds_read_b128 v[100:103], v251 offset:11456
    v_mfma_f32_32x32x16_f16 v[112:127], v[204:207], v[68:71], v[112:127]
    v_cvt_pk_bf16_f32 v153, |v130|, |v131|
    v_cvt_pk_bf16_f32 v154, |v132|, |v133|
    v_cvt_pk_bf16_f32 v155, |v134|, |v135|
    v_cvt_pk_bf16_f32 v156, |v136|, |v137|
    v_cvt_pk_bf16_f32 v157, |v138|, |v139|
    v_cvt_pk_bf16_f32 v158, |v140|, |v141|
    v_mfma_f32_16x16x32_f16 v[188:191], v[232:235], v[64:67], v[188:191]
    v_cvt_pk_bf16_f32 v159, |v142|, |v143|
    v_pk_mul_f16 v61, v109, v77
    v_mfma_f32_16x16x32_f16 v[188:191], v[236:239], v[68:71], v[188:191]
    v_pk_mul_f16 v62, v110, v78
    v_pk_mul_f16 v63, v111, v79
    v_smfmac_f32_16x16x64_bf16 v[184:187], v[228:231], v[144:151], v250
    v_mfma_f32_32x32x16_f16 v[128:143], v[200:203], v[56:59], v[208:223]
    s_waitcnt lgkmcnt(4)
    v_pk_mul_f16 v64, v104, v80
    v_pk_mul_f16 v65, v105, v81
    v_pk_mul_f16 v66, v106, v82
    v_pk_mul_f16 v67, v107, v83
    v_pk_mul_f16 v68, v108, v84
    v_pk_mul_f16 v69, v109, v85
    ds_read_b128 v[72:75], v251 offset:144
    ds_read_b128 v[76:79], v251 offset:11472
    v_mfma_f32_32x32x16_f16 v[128:143], v[204:207], v[60:63], v[128:143]
    v_permlane32_swap_b32 v184, v185
    v_add_f32 v184, v184, v185
    v_exp_f32 v242, v184
    v_cvt_pk_bf16_f32 v144, |v112|, |v113|
    v_smfmac_f32_16x16x64_bf16 v[188:191], v[224:227], v[152:159], v250
    v_add_f32 v240, v240, v242
    v_fmac_f32 v241, v242, v186
    v_mfma_f32_16x16x32_f16 v[184:187], v[176:179], v[56:59], 0
    v_cvt_pk_bf16_f32 v145, |v114|, |v115|
    v_cvt_pk_bf16_f32 v146, |v116|, |v117|
    v_mfma_f32_16x16x32_f16 v[184:187], v[180:183], v[60:63], v[184:187]
    v_cvt_pk_bf16_f32 v147, |v118|, |v119|
    v_cvt_pk_bf16_f32 v148, |v120|, |v121|
    v_cvt_pk_bf16_f32 v149, |v122|, |v123|
    v_cvt_pk_bf16_f32 v150, |v124|, |v125|
    v_cvt_pk_bf16_f32 v151, |v126|, |v127|
    v_pk_mul_f16 v70, v110, v86
    v_pk_mul_f16 v71, v111, v87
    v_mfma_f32_32x32x16_f16 v[112:127], v[200:203], v[64:67], v[208:223]
    s_waitcnt lgkmcnt(4)
    v_pk_mul_f16 v56, v104, v88
    v_pk_mul_f16 v57, v105, v89
    v_pk_mul_f16 v58, v106, v90
    v_pk_mul_f16 v59, v107, v91
    v_pk_mul_f16 v60, v108, v92
    v_cvt_pk_bf16_f32 v152, |v128|, |v129|
    ds_read_b128 v[80:83], v251 offset:160
    ds_read_b128 v[84:87], v251 offset:11488
    v_mfma_f32_32x32x16_f16 v[112:127], v[204:207], v[68:71], v[112:127]
    v_cvt_pk_bf16_f32 v153, |v130|, |v131|
    v_cvt_pk_bf16_f32 v154, |v132|, |v133|
    v_cvt_pk_bf16_f32 v155, |v134|, |v135|
    v_cvt_pk_bf16_f32 v156, |v136|, |v137|
    v_cvt_pk_bf16_f32 v157, |v138|, |v139|
    v_cvt_pk_bf16_f32 v158, |v140|, |v141|
    v_mfma_f32_16x16x32_f16 v[184:187], v[232:235], v[64:67], v[184:187]
    v_cvt_pk_bf16_f32 v159, |v142|, |v143|
    v_pk_mul_f16 v61, v109, v93
    v_mfma_f32_16x16x32_f16 v[184:187], v[236:239], v[68:71], v[184:187]
    v_pk_mul_f16 v62, v110, v94
    v_pk_mul_f16 v63, v111, v95
    v_smfmac_f32_16x16x64_bf16 v[188:191], v[228:231], v[144:151], v250
    v_add_u32 v251, 64, v251
    s_sub_u32 s24, s24, 1
    s_cmp_lg_u32 s24, 0
    s_cbranch_scc1 L_qloop
    v_mfma_f32_32x32x16_f16 v[128:143], v[200:203], v[56:59], v[208:223]
L_waitp:
    ds_read_b32 v254, v252 offset:12
    s_waitcnt lgkmcnt(3)
    ds_read_b128 v[72:75], v1 offset:0
    ds_read_b128 v[76:79], v1 offset:11328
    ds_read_b128 v[88:91], v1 offset:16
    ds_read_b128 v[92:95], v1 offset:11344
    s_waitcnt lgkmcnt(4)
    v_cmp_eq_u32 vcc, 0, v254
    s_cbranch_vccnz L_waitp
    ds_read_b128 v[96:99], v2 offset:0
    ds_read_b128 v[100:103], v2 offset:11328
    ds_read_b128 v[80:83], v2 offset:32
    ds_read_b128 v[84:87], v2 offset:11360
    v_permlane32_swap_b32 v188, v189
    v_add_f32 v188, v188, v189
    v_exp_f32 v242, v188
    v_cvt_pk_bf16_f32 v144, |v112|, |v113|
    v_mfma_f32_32x32x16_f16 v[128:143], v[204:207], v[60:63], v[128:143]
    v_add_f32 v240, v240, v242
    v_fmac_f32 v241, v242, v190
    v_cvt_pk_bf16_f32 v145, |v114|, |v115|
    v_cvt_pk_bf16_f32 v146, |v116|, |v117|
    v_cvt_pk_bf16_f32 v147, |v118|, |v119|
    v_cvt_pk_bf16_f32 v148, |v120|, |v121|
    v_mfma_f32_16x16x32_f16 v[188:191], v[176:179], v[56:59], 0
    v_cvt_pk_bf16_f32 v149, |v122|, |v123|
    v_cvt_pk_bf16_f32 v150, |v124|, |v125|
    v_mfma_f32_16x16x32_f16 v[188:191], v[180:183], v[60:63], v[188:191]
    v_cvt_pk_bf16_f32 v151, |v126|, |v127|
    s_waitcnt lgkmcnt(4)
    v_pk_mul_f16 v64, v72, v88
    v_smfmac_f32_16x16x64_bf16 v[184:187], v[224:227], v[152:159], v250
    v_pk_mul_f16 v65, v73, v89
    v_pk_mul_f16 v66, v74, v90
    v_pk_mul_f16 v67, v75, v91
    v_pk_mul_f16 v68, v76, v92
    v_pk_mul_f16 v69, v77, v93
    v_pk_mul_f16 v70, v78, v94
    v_pk_mul_f16 v71, v79, v95
    v_mfma_f32_32x32x16_f16 v[112:127], v[200:203], v[64:67], v[208:223]
    s_waitcnt lgkmcnt(0)
    v_pk_mul_f16 v56, v96, v80
    v_pk_mul_f16 v57, v97, v81
    v_pk_mul_f16 v58, v98, v82
    v_pk_mul_f16 v59, v99, v83
    v_pk_mul_f16 v60, v100, v84
    v_cvt_pk_bf16_f32 v152, |v128|, |v129|
    ds_read_b128 v[72:75], v3 offset:48
    ds_read_b128 v[76:79], v3 offset:11376
    ds_read_b128 v[88:91], v4 offset:0
    ds_read_b128 v[92:95], v4 offset:11328
    v_mfma_f32_32x32x16_f16 v[112:127], v[204:207], v[68:71], v[112:127]
    v_cvt_pk_bf16_f32 v153, |v130|, |v131|
    v_cvt_pk_bf16_f32 v154, |v132|, |v133|
    v_cvt_pk_bf16_f32 v155, |v134|, |v135|
    v_cvt_pk_bf16_f32 v156, |v136|, |v137|
    v_cvt_pk_bf16_f32 v157, |v138|, |v139|
    v_cvt_pk_bf16_f32 v158, |v140|, |v141|
    v_mfma_f32_16x16x32_f16 v[188:191], v[232:235], v[64:67], v[188:191]
    v_cvt_pk_bf16_f32 v159, |v142|, |v143|
    v_pk_mul_f16 v61, v101, v85
    v_mfma_f32_16x16x32_f16 v[188:191], v[236:239], v[68:71], v[188:191]
    v_pk_mul_f16 v62, v102, v86
    v_pk_mul_f16 v63, v103, v87
    v_smfmac_f32_16x16x64_bf16 v[184:187], v[228:231], v[144:151], v250
    v_mfma_f32_32x32x16_f16 v[128:143], v[200:203], v[56:59], v[208:223]
    s_waitcnt lgkmcnt(2)
    v_pk_mul_f16 v64, v96, v72
    v_pk_mul_f16 v65, v97, v73
    v_pk_mul_f16 v66, v98, v74
    v_pk_mul_f16 v67, v99, v75
    v_pk_mul_f16 v68, v100, v76
    v_pk_mul_f16 v69, v101, v77
    ds_read_b128 v[80:83], v5 offset:0
    ds_read_b128 v[84:87], v5 offset:11328
    v_mfma_f32_32x32x16_f16 v[128:143], v[204:207], v[60:63], v[128:143]
    v_permlane32_swap_b32 v184, v185
    v_add_f32 v184, v184, v185
    v_exp_f32 v242, v184
    v_cvt_pk_bf16_f32 v144, |v112|, |v113|
    v_smfmac_f32_16x16x64_bf16 v[188:191], v[224:227], v[152:159], v250
    v_add_f32 v240, v240, v242
    v_fmac_f32 v241, v242, v186
    v_mfma_f32_16x16x32_f16 v[184:187], v[176:179], v[56:59], 0
    v_cvt_pk_bf16_f32 v145, |v114|, |v115|
    v_cvt_pk_bf16_f32 v146, |v116|, |v117|
    v_mfma_f32_16x16x32_f16 v[184:187], v[180:183], v[60:63], v[184:187]
    v_cvt_pk_bf16_f32 v147, |v118|, |v119|
    v_cvt_pk_bf16_f32 v148, |v120|, |v121|
    v_cvt_pk_bf16_f32 v149, |v122|, |v123|
    v_cvt_pk_bf16_f32 v150, |v124|, |v125|
    v_cvt_pk_bf16_f32 v151, |v126|, |v127|
    v_pk_mul_f16 v70, v102, v78
    v_pk_mul_f16 v71, v103, v79
    v_mfma_f32_32x32x16_f16 v[112:127], v[200:203], v[64:67], v[208:223]
    s_waitcnt lgkmcnt(0)
    v_pk_mul_f16 v88, v88, v80
    v_pk_mul_f16 v89, v89, v81
    v_pk_mul_f16 v90, v90, v82
    v_pk_mul_f16 v91, v91, v83
    v_pk_mul_f16 v92, v92, v84
    v_cvt_pk_bf16_f32 v152, |v128|, |v129|
    ds_read_b128 v[72:75], v247 offset:64
    ds_read_b128 v[76:79], v247 offset:11392
    ds_read_b128 v[96:99], v246 offset:64
    ds_read_b128 v[100:103], v246 offset:11392
    v_mfma_f32_32x32x16_f16 v[112:127], v[204:207], v[68:71], v[112:127]
    v_cvt_pk_bf16_f32 v153, |v130|, |v131|
    v_cvt_pk_bf16_f32 v154, |v132|, |v133|
    v_cvt_pk_bf16_f32 v155, |v134|, |v135|
    v_cvt_pk_bf16_f32 v156, |v136|, |v137|
    v_cvt_pk_bf16_f32 v157, |v138|, |v139|
    v_cvt_pk_bf16_f32 v158, |v140|, |v141|
    v_mfma_f32_16x16x32_f16 v[184:187], v[232:235], v[64:67], v[184:187]
    v_cvt_pk_bf16_f32 v159, |v142|, |v143|
    v_pk_mul_f16 v93, v93, v85
    v_mfma_f32_16x16x32_f16 v[184:187], v[236:239], v[68:71], v[184:187]
    v_pk_mul_f16 v94, v94, v86
    v_pk_mul_f16 v95, v95, v87
    v_smfmac_f32_16x16x64_bf16 v[188:191], v[228:231], v[144:151], v250
    v_mfma_f32_32x32x16_f16 v[128:143], v[200:203], v[88:91], v[208:223]
    s_waitcnt lgkmcnt(2)
    v_pk_mul_f16 v56, v8, v72
    v_pk_mul_f16 v57, v9, v73
    v_pk_mul_f16 v58, v10, v74
    v_pk_mul_f16 v59, v11, v75
    v_pk_mul_f16 v60, v12, v76
    v_pk_mul_f16 v61, v13, v77
    ds_read_b128 v[80:83], v247 offset:96
    ds_read_b128 v[84:87], v247 offset:11424
    ds_read_b128 v[232:235], v249 offset:64
    ds_read_b128 v[236:239], v249 offset:11392
    v_mfma_f32_32x32x16_f16 v[128:143], v[204:207], v[92:95], v[128:143]
    v_permlane32_swap_b32 v188, v189
    v_add_f32 v188, v188, v189
    v_exp_f32 v242, v188
    v_cvt_pk_bf16_f32 v144, |v112|, |v113|
    v_smfmac_f32_16x16x64_bf16 v[184:187], v[224:227], v[152:159], v250
    v_add_f32 v240, v240, v242
    v_fmac_f32 v241, v242, v190
    v_mfma_f32_16x16x32_f16 v[188:191], v[176:179], v[88:91], 0
    v_cvt_pk_bf16_f32 v145, |v114|, |v115|
    v_cvt_pk_bf16_f32 v146, |v116|, |v117|
    v_mfma_f32_16x16x32_f16 v[188:191], v[180:183], v[92:95], v[188:191]
    v_cvt_pk_bf16_f32 v147, |v118|, |v119|
    v_cvt_pk_bf16_f32 v148, |v120|, |v121|
    v_cvt_pk_bf16_f32 v149, |v122|, |v123|
    v_cvt_pk_bf16_f32 v150, |v124|, |v125|
    v_cvt_pk_bf16_f32 v151, |v126|, |v127|
    v_pk_mul_f16 v62, v14, v78
    v_pk_mul_f16 v63, v15, v79
    ds_read_b128 v[176:179], v248 offset:64
    ds_read_b128 v[180:183], v248 offset:11392
    s_waitcnt lgkmcnt(6)
    v_mfma_f32_32x32x16_f16 v[112:127], v[56:59], v[96:99], v[24:39]
    s_waitcnt lgkmcnt(4)
    v_pk_mul_f16 v64, v8, v80
    v_pk_mul_f16 v65, v9, v81
    v_pk_mul_f16 v66, v10, v82
    v_pk_mul_f16 v67, v11, v83
    v_pk_mul_f16 v68, v12, v84
    v_cvt_pk_bf16_f32 v152, |v128|, |v129|
    v_mfma_f32_32x32x16_f16 v[112:127], v[60:63], v[100:103], v[112:127]
    v_cvt_pk_bf16_f32 v153, |v130|, |v131|
    v_cvt_pk_bf16_f32 v154, |v132|, |v133|
    v_cvt_pk_bf16_f32 v155, |v134|, |v135|
    v_cvt_pk_bf16_f32 v156, |v136|, |v137|
    v_cvt_pk_bf16_f32 v157, |v138|, |v139|
    v_cvt_pk_bf16_f32 v158, |v140|, |v141|
    v_smfmac_f32_16x16x64_bf16 v[184:187], v[228:231], v[144:151], v250
    v_cvt_pk_bf16_f32 v159, |v142|, |v143|
    s_waitcnt lgkmcnt(2)
    v_mfma_f32_32x32x16_f16 v[200:215], v[232:235], v[104:107], 0
    v_mfma_f32_32x32x16_f16 v[200:215], v[236:239], v[108:111], v[200:215]
    v_mfma_f32_32x32x16_f16 v[128:143], v[56:59], v[104:107], v[24:39]
    v_pk_mul_f16 v69, v13, v85
    v_pk_mul_f16 v70, v14, v86
    v_pk_mul_f16 v71, v15, v87
    ds_read_b128 v[88:91], v246 offset:128
    ds_read_b128 v[92:95], v246 offset:11456
    v_mfma_f32_32x32x16_f16 v[128:143], v[60:63], v[108:111], v[128:143]
    v_cvt_pk_bf16_f32 v144, |v112|, |v113|
    v_cvt_pk_bf16_f32 v145, |v114|, |v115|
    v_cvt_pk_bf16_f32 v146, |v116|, |v117|
    v_cvt_pk_bf16_f32 v147, |v118|, |v119|
    v_cvt_pk_bf16_f32 v148, |v120|, |v121|
    v_cvt_pk_bf16_f32 v149, |v122|, |v123|
    s_waitcnt lgkmcnt(2)
    v_mfma_f32_16x16x32_f16 v[192:195], v[176:179], v[96:99], 0
    v_cvt_pk_bf16_f32 v150, |v124|, |v125|
    v_cvt_pk_bf16_f32 v151, |v126|, |v127|
    v_mfma_f32_16x16x32_f16 v[192:195], v[180:183], v[100:103], v[192:195]
    v_permlane32_swap_b32 v184, v185
    v_smfmac_f32_16x16x64_bf16 v[188:191], v[224:227], v[152:159], v250
    v_add_f32 v184, v184, v185
    v_exp_f32 v242, v184
    s_nop 0
    v_add_f32 v240, v240, v242
    v_fmac_f32 v241, v242, v186
    v_mfma_f32_32x32x16_f16 v[112:127], v[64:67], v[96:99], v[24:39]
    v_pk_mul_f16 v56, v16, v72
    v_pk_mul_f16 v57, v17, v73
    v_pk_mul_f16 v58, v18, v74
    v_pk_mul_f16 v59, v19, v75
    ds_read_b128 v[176:179], v248 offset:128
    ds_read_b128 v[180:183], v248 offset:11456
    v_mfma_f32_32x32x16_f16 v[112:127], v[68:71], v[100:103], v[112:127]
    v_cvt_pk_bf16_f32 v152, |v128|, |v129|
    v_cvt_pk_bf16_f32 v153, |v130|, |v131|
    v_cvt_pk_bf16_f32 v154, |v132|, |v133|
    v_cvt_pk_bf16_f32 v155, |v134|, |v135|
    v_cvt_pk_bf16_f32 v156, |v136|, |v137|
    v_cvt_pk_bf16_f32 v157, |v138|, |v139|
    v_smfmac_f32_16x16x64_bf16 v[192:195], v[160:163], v[144:151], v250
    v_cvt_pk_bf16_f32 v158, |v140|, |v141|
    v_cvt_pk_bf16_f32 v159, |v142|, |v143|
    v_permlane32_swap_b32 v188, v189
    v_add_f32 v188, v188, v189
    v_exp_f32 v242, v188
    s_mov_b64 exec, 0x3fffff
    v_add_f32 v240, v240, v242
    v_fmac_f32 v241, v242, v190
    s_mov_b64 exec, -1
    v_mfma_f32_32x32x16_f16 v[128:143], v[64:67], v[104:107], v[24:39]
    v_pk_mul_f16 v60, v20, v76
    v_pk_mul_f16 v61, v21, v77
    v_pk_mul_f16 v62, v22, v78
    v_pk_mul_f16 v63, v23, v79
    v_mfma_f32_32x32x16_f16 v[128:143], v[68:71], v[108:111], v[128:143]
    v_cvt_pk_bf16_f32 v144, |v112|, |v113|
    v_cvt_pk_bf16_f32 v145, |v114|, |v115|
    v_cvt_pk_bf16_f32 v146, |v116|, |v117|
    v_cvt_pk_bf16_f32 v147, |v118|, |v119|
    v_cvt_pk_bf16_f32 v148, |v120|, |v121|
    v_cvt_pk_bf16_f32 v149, |v122|, |v123|
    v_smfmac_f32_16x16x64_bf16 v[200:203], v[160:163], v[152:159], v250
    v_cvt_pk_bf16_f32 v150, |v124|, |v125|
    v_cvt_pk_bf16_f32 v151, |v126|, |v127|
    v_mfma_f32_32x32x16_f16 v[112:127], v[56:59], v[96:99], v[40:55]
    v_pk_mul_f16 v64, v16, v80
    v_pk_mul_f16 v65, v17, v81
    v_pk_mul_f16 v66, v18, v82
    ds_read_b128 v[72:75], v247 offset:128
    ds_read_b128 v[76:79], v247 offset:11456
    v_mfma_f32_32x32x16_f16 v[112:127], v[60:63], v[100:103], v[112:127]
    v_cvt_pk_bf16_f32 v152, |v128|, |v129|
    v_cvt_pk_bf16_f32 v153, |v130|, |v131|
    v_cvt_pk_bf16_f32 v154, |v132|, |v133|
    v_cvt_pk_bf16_f32 v155, |v134|, |v135|
    v_cvt_pk_bf16_f32 v156, |v136|, |v137|
    v_cvt_pk_bf16_f32 v157, |v138|, |v139|
    v_smfmac_f32_16x16x64_bf16 v[192:195], v[168:171], v[144:151], v250
    v_cvt_pk_bf16_f32 v158, |v140|, |v141|
    v_cvt_pk_bf16_f32 v159, |v142|, |v143|
    v_mfma_f32_32x32x16_f16 v[128:143], v[56:59], v[104:107], v[40:55]
    v_pk_mul_f16 v67, v19, v83
    v_pk_mul_f16 v68, v20, v84
    v_pk_mul_f16 v69, v21, v85
    v_pk_mul_f16 v70, v22, v86
    v_pk_mul_f16 v71, v23, v87
    v_cvt_pk_bf16_f32 v144, |v112|, |v113|
    v_mfma_f32_32x32x16_f16 v[128:143], v[60:63], v[108:111], v[128:143]
    v_cvt_pk_bf16_f32 v145, |v114|, |v115|
    v_cvt_pk_bf16_f32 v146, |v116|, |v117|
    v_cvt_pk_bf16_f32 v147, |v118|, |v119|
    v_cvt_pk_bf16_f32 v148, |v120|, |v121|
    v_cvt_pk_bf16_f32 v149, |v122|, |v123|
    v_cvt_pk_bf16_f32 v150, |v124|, |v125|
    v_smfmac_f32_16x16x64_bf16 v[200:203], v[168:171], v[152:159], v250
    v_cvt_pk_bf16_f32 v151, |v126|, |v127|
    v_mfma_f32_32x32x16_f16 v[112:127], v[64:67], v[96:99], v[40:55]
    s_waitcnt lgkmcnt(0)
    v_pk_mul_f16 v56, v8, v72
    v_pk_mul_f16 v57, v9, v73
    v_pk_mul_f16 v58, v10, v74
    v_pk_mul_f16 v59, v11, v75
    ds_read_b128 v[80:83], v247 offset:160
    ds_read_b128 v[84:87], v247 offset:11488
    v_mfma_f32_32x32x16_f16 v[112:127], v[68:71], v[100:103], v[112:127]
    v_cvt_pk_bf16_f32 v152, |v128|, |v129|
    v_cvt_pk_bf16_f32 v153, |v130|, |v131|
    v_cvt_pk_bf16_f32 v154, |v132|, |v133|
    v_cvt_pk_bf16_f32 v155, |v134|, |v135|
    v_cvt_pk_bf16_f32 v156, |v136|, |v137|
    v_cvt_pk_bf16_f32 v157, |v138|, |v139|
    v_smfmac_f32_16x16x64_bf16 v[192:195], v[164:167], v[144:151], v250
    v_cvt_pk_bf16_f32 v158, |v140|, |v141|
    v_cvt_pk_bf16_f32 v159, |v142|, |v143|
    v_mfma_f32_32x32x16_f16 v[128:143], v[64:67], v[104:107], v[40:55]
    v_pk_mul_f16 v60, v12, v76
    v_pk_mul_f16 v61, v13, v77
    v_pk_mul_f16 v62, v14, v78
    v_pk_mul_f16 v63, v15, v79
    v_mfma_f32_32x32x16_f16 v[128:143], v[68:71], v[108:111], v[128:143]
    v_cvt_pk_bf16_f32 v144, |v112|, |v113|
    v_cvt_pk_bf16_f32 v145, |v114|, |v115|
    v_cvt_pk_bf16_f32 v146, |v116|, |v117|
    v_cvt_pk_bf16_f32 v147, |v118|, |v119|
    v_cvt_pk_bf16_f32 v148, |v120|, |v121|
    v_cvt_pk_bf16_f32 v149, |v122|, |v123|
    v_smfmac_f32_16x16x64_bf16 v[200:203], v[164:167], v[152:159], v250
    v_cvt_pk_bf16_f32 v150, |v124|, |v125|
    v_cvt_pk_bf16_f32 v151, |v126|, |v127|
L_mid1:
    v_mfma_f32_32x32x16_f16 v[112:127], v[56:59], v[88:91], v[24:39]
    s_waitcnt lgkmcnt(0)
    v_pk_mul_f16 v64, v8, v80
    v_pk_mul_f16 v65, v9, v81
    v_pk_mul_f16 v66, v10, v82
    v_pk_mul_f16 v67, v11, v83
    v_pk_mul_f16 v68, v12, v84
    v_cvt_pk_bf16_f32 v152, |v128|, |v129|
    v_mfma_f32_32x32x16_f16 v[112:127], v[60:63], v[92:95], v[112:127]
    v_cvt_pk_bf16_f32 v153, |v130|, |v131|
    v_cvt_pk_bf16_f32 v154, |v132|, |v133|
    v_cvt_pk_bf16_f32 v155, |v134|, |v135|
    v_cvt_pk_bf16_f32 v156, |v136|, |v137|
    v_cvt_pk_bf16_f32 v157, |v138|, |v139|
    v_cvt_pk_bf16_f32 v158, |v140|, |v141|
    v_smfmac_f32_16x16x64_bf16 v[192:195], v[172:175], v[144:151], v250
    v_cvt_pk_bf16_f32 v159, |v142|, |v143|
    v_mfma_f32_32x32x16_f16 v[128:143], v[56:59], v[104:107], v[24:39]
    v_pk_mul_f16 v69, v13, v85
    v_pk_mul_f16 v70, v14, v86
    v_pk_mul_f16 v71, v15, v87
    v_cvt_pk_bf16_f32 v144, |v112|, |v113|
    v_cvt_pk_bf16_f32 v145, |v114|, |v115|
    v_cvt_pk_bf16_f32 v146, |v116|, |v117|
    ds_read_b128 v[96:99], v246 offset:192
    ds_read_b128 v[100:103], v246 offset:11520
    v_mfma_f32_32x32x16_f16 v[128:143], v[60:63], v[108:111], v[128:143]
    v_cvt_pk_bf16_f32 v147, |v118|, |v119|
    v_cvt_pk_bf16_f32 v148, |v120|, |v121|
    v_cvt_pk_bf16_f32 v149, |v122|, |v123|
    v_cvt_pk_bf16_f32 v150, |v124|, |v125|
    v_cvt_pk_bf16_f32 v151, |v126|, |v127|
    v_exp_f32 v242, v192
    v_mfma_f32_16x16x32_f16 v[184:187], v[176:179], v[88:91], 0
    v_exp_f32 v243, v193
    v_mfma_f32_16x16x32_f16 v[184:187], v[180:183], v[92:95], v[184:187]
    v_add_f32 v240, v240, v242
    v_smfmac_f32_16x16x64_bf16 v[200:203], v[172:175], v[152:159], v250
    v_mfma_f32_32x32x16_f16 v[112:127], v[64:67], v[88:91], v[24:39]
    v_pk_mul_f16 v56, v16, v72
    v_pk_mul_f16 v57, v17, v73
    v_pk_mul_f16 v58, v18, v74
    v_pk_mul_f16 v59, v19, v75
    v_cvt_pk_bf16_f32 v152, |v128|, |v129|
    v_cvt_pk_bf16_f32 v153, |v130|, |v131|
    ds_read_b128 v[176:179], v248 offset:192
    ds_read_b128 v[180:183], v248 offset:11520
    v_mfma_f32_32x32x16_f16 v[112:127], v[68:71], v[92:95], v[112:127]
    v_cvt_pk_bf16_f32 v154, |v132|, |v133|
    v_cvt_pk_bf16_f32 v155, |v134|, |v135|
    v_cvt_pk_bf16_f32 v156, |v136|, |v137|
    v_cvt_pk_bf16_f32 v157, |v138|, |v139|
    v_cvt_pk_bf16_f32 v158, |v140|, |v141|
    v_cvt_pk_bf16_f32 v159, |v142|, |v143|
    v_smfmac_f32_16x16x64_bf16 v[184:187], v[160:163], v[144:151], v250
    v_exp_f32 v244, v200
    v_mfma_f32_32x32x16_f16 v[128:143], v[64:67], v[104:107], v[24:39]
    v_pk_mul_f16 v60, v20, v76
    v_pk_mul_f16 v61, v21, v77
    v_pk_mul_f16 v62, v22, v78
    v_pk_mul_f16 v63, v23, v79
    v_add_f32 v240, v240, v244
    v_cvt_pk_bf16_f32 v144, |v112|, |v113|
    v_mfma_f32_32x32x16_f16 v[128:143], v[68:71], v[108:111], v[128:143]
    v_cvt_pk_bf16_f32 v145, |v114|, |v115|
    v_cvt_pk_bf16_f32 v146, |v116|, |v117|
    v_cvt_pk_bf16_f32 v147, |v118|, |v119|
    v_cvt_pk_bf16_f32 v148, |v120|, |v121|
    v_cvt_pk_bf16_f32 v149, |v122|, |v123|
    v_cvt_pk_bf16_f32 v150, |v124|, |v125|
    v_smfmac_f32_16x16x64_bf16 v[204:207], v[160:163], v[152:159], v250
    v_cvt_pk_bf16_f32 v151, |v126|, |v127|
    v_mfma_f32_32x32x16_f16 v[112:127], v[56:59], v[88:91], v[40:55]
    v_pk_mul_f16 v64, v16, v80
    v_pk_mul_f16 v65, v17, v81
    v_pk_mul_f16 v66, v18, v82
    v_exp_f32 v245, v201
    v_cvt_pk_bf16_f32 v152, |v128|, |v129|
    ds_read_b128 v[72:75], v247 offset:192
    ds_read_b128 v[76:79], v247 offset:11520
    v_mfma_f32_32x32x16_f16 v[112:127], v[60:63], v[92:95], v[112:127]
    v_cvt_pk_bf16_f32 v153, |v130|, |v131|
    v_cvt_pk_bf16_f32 v154, |v132|, |v133|
    v_cvt_pk_bf16_f32 v155, |v134|, |v135|
    v_cvt_pk_bf16_f32 v156, |v136|, |v137|
    v_cvt_pk_bf16_f32 v157, |v138|, |v139|
    v_cvt_pk_bf16_f32 v158, |v140|, |v141|
    v_smfmac_f32_16x16x64_bf16 v[184:187], v[168:171], v[144:151], v250
    v_cvt_pk_bf16_f32 v159, |v142|, |v143|
    v_fmac_f32 v241, v244, v202
    v_mfma_f32_32x32x16_f16 v[128:143], v[56:59], v[104:107], v[40:55]
    v_pk_mul_f16 v67, v19, v83
    v_pk_mul_f16 v68, v20, v84
    v_pk_mul_f16 v69, v21, v85
    v_pk_mul_f16 v70, v22, v86
    v_pk_mul_f16 v71, v23, v87
    v_cvt_pk_bf16_f32 v144, |v112|, |v113|
    v_mfma_f32_32x32x16_f16 v[128:143], v[60:63], v[108:111], v[128:143]
    v_cvt_pk_bf16_f32 v145, |v114|, |v115|
    v_cvt_pk_bf16_f32 v146, |v116|, |v117|
    v_cvt_pk_bf16_f32 v147, |v118|, |v119|
    v_cvt_pk_bf16_f32 v148, |v120|, |v121|
    v_cvt_pk_bf16_f32 v149, |v122|, |v123|
    v_cvt_pk_bf16_f32 v150, |v124|, |v125|
    v_smfmac_f32_16x16x64_bf16 v[204:207], v[168:171], v[152:159], v250
    v_cvt_pk_bf16_f32 v151, |v126|, |v127|
    v_add_f32 v240, v240, v245
    v_mfma_f32_32x32x16_f16 v[112:127], v[64:67], v[88:91], v[40:55]
    s_waitcnt lgkmcnt(0)
    v_pk_mul_f16 v56, v8, v72
    v_pk_mul_f16 v57, v9, v73
    v_pk_mul_f16 v58, v10, v74
    v_pk_mul_f16 v59, v11, v75
    v_fmac_f32 v241, v242, v194
    v_cvt_pk_bf16_f32 v152, |v128|, |v129|
    ds_read_b128 v[80:83], v247 offset:224
    ds_read_b128 v[84:87], v247 offset:11552
    v_mfma_f32_32x32x16_f16 v[112:127], v[68:71], v[92:95], v[112:127]
    v_cvt_pk_bf16_f32 v153, |v130|, |v131|
    v_cvt_pk_bf16_f32 v154, |v132|, |v133|
    v_cvt_pk_bf16_f32 v155, |v134|, |v135|
    v_cvt_pk_bf16_f32 v156, |v136|, |v137|
    v_cvt_pk_bf16_f32 v157, |v138|, |v139|
    v_cvt_pk_bf16_f32 v158, |v140|, |v141|
    v_smfmac_f32_16x16x64_bf16 v[184:187], v[164:167], v[144:151], v250
    v_cvt_pk_bf16_f32 v159, |v142|, |v143|
    v_fmac_f32 v241, v245, v203
    v_mfma_f32_32x32x16_f16 v[128:143], v[64:67], v[104:107], v[40:55]
    v_pk_mul_f16 v60, v12, v76
    v_pk_mul_f16 v61, v13, v77
    v_pk_mul_f16 v62, v14, v78
    v_pk_mul_f16 v63, v15, v79
    v_add_f32 v240, v240, v243
    v_cvt_pk_bf16_f32 v144, |v112|, |v113|
    v_mfma_f32_32x32x16_f16 v[128:143], v[68:71], v[108:111], v[128:143]
    v_cvt_pk_bf16_f32 v145, |v114|, |v115|
    v_cvt_pk_bf16_f32 v146, |v116|, |v117|
    v_cvt_pk_bf16_f32 v147, |v118|, |v119|
    v_cvt_pk_bf16_f32 v148, |v120|, |v121|
    v_cvt_pk_bf16_f32 v149, |v122|, |v123|
    v_cvt_pk_bf16_f32 v150, |v124|, |v125|
    v_smfmac_f32_16x16x64_bf16 v[204:207], v[164:167], v[152:159], v250
    v_cvt_pk_bf16_f32 v151, |v126|, |v127|
    v_fmac_f32 v241, v243, v195
    v_mfma_f32_32x32x16_f16 v[112:127], v[56:59], v[96:99], v[24:39]
    s_waitcnt lgkmcnt(0)
    v_pk_mul_f16 v64, v8, v80
    v_pk_mul_f16 v65, v9, v81
    v_pk_mul_f16 v66, v10, v82
    v_pk_mul_f16 v67, v11, v83
    v_pk_mul_f16 v68, v12, v84
    v_cvt_pk_bf16_f32 v152, |v128|, |v129|
    v_mfma_f32_32x32x16_f16 v[112:127], v[60:63], v[100:103], v[112:127]
    v_cvt_pk_bf16_f32 v153, |v130|, |v131|
    v_cvt_pk_bf16_f32 v154, |v132|, |v133|
    v_cvt_pk_bf16_f32 v155, |v134|, |v135|
    v_cvt_pk_bf16_f32 v156, |v136|, |v137|
    v_cvt_pk_bf16_f32 v157, |v138|, |v139|
    v_cvt_pk_bf16_f32 v158, |v140|, |v141|
    v_smfmac_f32_16x16x64_bf16 v[184:187], v[172:175], v[144:151], v250
    v_cvt_pk_bf16_f32 v159, |v142|, |v143|
    v_mfma_f32_32x32x16_f16 v[128:143], v[56:59], v[104:107], v[24:39]
    v_pk_mul_f16 v69, v13, v85
    v_pk_mul_f16 v70, v14, v86
    v_pk_mul_f16 v71, v15, v87
    v_cvt_pk_bf16_f32 v144, |v112|, |v113|
    v_cvt_pk_bf16_f32 v145, |v114|, |v115|
    v_cvt_pk_bf16_f32 v146, |v116|, |v117|
    ds_read_b128 v[88:91], v246 offset:256
    ds_read_b128 v[92:95], v246 offset:11584
    v_mfma_f32_32x32x16_f16 v[128:143], v[60:63], v[108:111], v[128:143]
    v_cvt_pk_bf16_f32 v147, |v118|, |v119|
    v_cvt_pk_bf16_f32 v148, |v120|, |v121|
    v_cvt_pk_bf16_f32 v149, |v122|, |v123|
    v_cvt_pk_bf16_f32 v150, |v124|, |v125|
    v_cvt_pk_bf16_f32 v151, |v126|, |v127|
    v_exp_f32 v242, v184
    v_mfma_f32_16x16x32_f16 v[192:195], v[176:179], v[96:99], 0
    v_exp_f32 v243, v185
    v_mfma_f32_16x16x32_f16 v[192:195], v[180:183], v[100:103], v[192:195]
    v_add_f32 v240, v240, v242
    v_smfmac_f32_16x16x64_bf16 v[204:207], v[172:175], v[152:159], v250
    v_mfma_f32_32x32x16_f16 v[112:127], v[64:67], v[96:99], v[24:39]
    v_pk_mul_f16 v56, v16, v72
    v_pk_mul_f16 v57, v17, v73
    v_pk_mul_f16 v58, v18, v74
    v_pk_mul_f16 v59, v19, v75
    v_cvt_pk_bf16_f32 v152, |v128|, |v129|
    v_cvt_pk_bf16_f32 v153, |v130|, |v131|
    ds_read_b128 v[176:179], v248 offset:256
    ds_read_b128 v[180:183], v248 offset:11584
    v_mfma_f32_32x32x16_f16 v[112:127], v[68:71], v[100:103], v[112:127]
    v_cvt_pk_bf16_f32 v154, |v132|, |v133|
    v_cvt_pk_bf16_f32 v155, |v134|, |v135|
    v_cvt_pk_bf16_f32 v156, |v136|, |v137|
    v_cvt_pk_bf16_f32 v157, |v138|, |v139|
    v_cvt_pk_bf16_f32 v158, |v140|, |v141|
    v_cvt_pk_bf16_f32 v159, |v142|, |v143|
    v_smfmac_f32_16x16x64_bf16 v[192:195], v[160:163], v[144:151], v250
    v_exp_f32 v244, v204
    v_mfma_f32_32x32x16_f16 v[128:143], v[64:67], v[104:107], v[24:39]
    v_pk_mul_f16 v60, v20, v76
    v_pk_mul_f16 v61, v21, v77
    v_pk_mul_f16 v62, v22, v78
    v_pk_mul_f16 v63, v23, v79
    v_add_f32 v240, v240, v244
    v_cvt_pk_bf16_f32 v144, |v112|, |v113|
    v_mfma_f32_32x32x16_f16 v[128:143], v[68:71], v[108:111], v[128:143]
    v_cvt_pk_bf16_f32 v145, |v114|, |v115|
    v_cvt_pk_bf16_f32 v146, |v116|, |v117|
    v_cvt_pk_bf16_f32 v147, |v118|, |v119|
    v_cvt_pk_bf16_f32 v148, |v120|, |v121|
    v_cvt_pk_bf16_f32 v149, |v122|, |v123|
    v_cvt_pk_bf16_f32 v150, |v124|, |v125|
    v_smfmac_f32_16x16x64_bf16 v[208:211], v[160:163], v[152:159], v250
    v_cvt_pk_bf16_f32 v151, |v126|, |v127|
    v_mfma_f32_32x32x16_f16 v[112:127], v[56:59], v[96:99], v[40:55]
    v_pk_mul_f16 v64, v16, v80
    v_pk_mul_f16 v65, v17, v81
    v_pk_mul_f16 v66, v18, v82
    v_exp_f32 v245, v205
    v_cvt_pk_bf16_f32 v152, |v128|, |v129|
    ds_read_b128 v[72:75], v247 offset:256
    ds_read_b128 v[76:79], v247 offset:11584
    v_mfma_f32_32x32x16_f16 v[112:127], v[60:63], v[100:103], v[112:127]
    v_cvt_pk_bf16_f32 v153, |v130|, |v131|
    v_cvt_pk_bf16_f32 v154, |v132|, |v133|
    v_cvt_pk_bf16_f32 v155, |v134|, |v135|
    v_cvt_pk_bf16_f32 v156, |v136|, |v137|
    v_cvt_pk_bf16_f32 v157, |v138|, |v139|
    v_cvt_pk_bf16_f32 v158, |v140|, |v141|
    v_smfmac_f32_16x16x64_bf16 v[192:195], v[168:171], v[144:151], v250
    v_cvt_pk_bf16_f32 v159, |v142|, |v143|
    v_fmac_f32 v241, v244, v206
    v_mfma_f32_32x32x16_f16 v[128:143], v[56:59], v[104:107], v[40:55]
    v_pk_mul_f16 v67, v19, v83
    v_pk_mul_f16 v68, v20, v84
    v_pk_mul_f16 v69, v21, v85
    v_pk_mul_f16 v70, v22, v86
    v_pk_mul_f16 v71, v23, v87
    v_cvt_pk_bf16_f32 v144, |v112|, |v113|
    v_mfma_f32_32x32x16_f16 v[128:143], v[60:63], v[108:111], v[128:143]
    v_cvt_pk_bf16_f32 v145, |v114|, |v115|
    v_cvt_pk_bf16_f32 v146, |v116|, |v117|
    v_cvt_pk_bf16_f32 v147, |v118|, |v119|
    v_cvt_pk_bf16_f32 v148, |v120|, |v121|
    v_cvt_pk_bf16_f32 v149, |v122|, |v123|
    v_cvt_pk_bf16_f32 v150, |v124|, |v125|
    v_smfmac_f32_16x16x64_bf16 v[208:211], v[168:171], v[152:159], v250
    v_cvt_pk_bf16_f32 v151, |v126|, |v127|
    v_add_f32 v240, v240, v245
    v_mfma_f32_32x32x16_f16 v[112:127], v[64:67], v[96:99], v[40:55]
    s_waitcnt lgkmcnt(0)
    v_pk_mul_f16 v56, v8, v72
    v_pk_mul_f16 v57, v9, v73
    v_pk_mul_f16 v58, v10, v74
    v_pk_mul_f16 v59, v11, v75
    v_fmac_f32 v241, v242, v186
    v_cvt_pk_bf16_f32 v152, |v128|, |v129|
    ds_read_b128 v[80:83], v247 offset:288
    ds_read_b128 v[84:87], v247 offset:11616
    v_mfma_f32_32x32x16_f16 v[112:127], v[68:71], v[100:103], v[112:127]
    v_cvt_pk_bf16_f32 v153, |v130|, |v131|
    v_cvt_pk_bf16_f32 v154, |v132|, |v133|
    v_cvt_pk_bf16_f32 v155, |v134|, |v135|
    v_cvt_pk_bf16_f32 v156, |v136|, |v137|
    v_cvt_pk_bf16_f32 v157, |v138|, |v139|
    v_cvt_pk_bf16_f32 v158, |v140|, |v141|
    v_smfmac_f32_16x16x64_bf16 v[192:195], v[164:167], v[144:151], v250
    v_cvt_pk_bf16_f32 v159, |v142|, |v143|
    v_fmac_f32 v241, v245, v207
    v_mfma_f32_32x32x16_f16 v[128:143], v[64:67], v[104:107], v[40:55]
    v_pk_mul_f16 v60, v12, v76
    v_pk_mul_f16 v61, v13, v77
    v_pk_mul_f16 v62, v14, v78
    v_pk_mul_f16 v63, v15, v79
    v_add_f32 v240, v240, v243
    v_cvt_pk_bf16_f32 v144, |v112|, |v113|
    v_mfma_f32_32x32x16_f16 v[128:143], v[68:71], v[108:111], v[128:143]
    v_cvt_pk_bf16_f32 v145, |v114|, |v115|
    v_cvt_pk_bf16_f32 v146, |v116|, |v117|
    v_cvt_pk_bf16_f32 v147, |v118|, |v119|
    v_cvt_pk_bf16_f32 v148, |v120|, |v121|
    v_cvt_pk_bf16_f32 v149, |v122|, |v123|
    v_cvt_pk_bf16_f32 v150, |v124|, |v125|
    v_smfmac_f32_16x16x64_bf16 v[208:211], v[164:167], v[152:159], v250
    v_cvt_pk_bf16_f32 v151, |v126|, |v127|
    v_fmac_f32 v241, v243, v187
    v_mfma_f32_32x32x16_f16 v[112:127], v[56:59], v[88:91], v[24:39]
    s_waitcnt lgkmcnt(0)
    v_pk_mul_f16 v64, v8, v80
    v_pk_mul_f16 v65, v9, v81
    v_pk_mul_f16 v66, v10, v82
    v_pk_mul_f16 v67, v11, v83
    v_pk_mul_f16 v68, v12, v84
    v_cvt_pk_bf16_f32 v152, |v128|, |v129|
    v_mfma_f32_32x32x16_f16 v[112:127], v[60:63], v[92:95], v[112:127]
    v_cvt_pk_bf16_f32 v153, |v130|, |v131|
    v_cvt_pk_bf16_f32 v154, |v132|, |v133|
    v_cvt_pk_bf16_f32 v155, |v134|, |v135|
    v_cvt_pk_bf16_f32 v156, |v136|, |v137|
    v_cvt_pk_bf16_f32 v157, |v138|, |v139|
    v_cvt_pk_bf16_f32 v158, |v140|, |v141|
    v_smfmac_f32_16x16x64_bf16 v[192:195], v[172:175], v[144:151], v250
    v_cvt_pk_bf16_f32 v159, |v142|, |v143|
    v_mfma_f32_32x32x16_f16 v[128:143], v[56:59], v[104:107], v[24:39]
    v_pk_mul_f16 v69, v13, v85
    v_pk_mul_f16 v70, v14, v86
    v_pk_mul_f16 v71, v15, v87
    v_cvt_pk_bf16_f32 v144, |v112|, |v113|
    ds_read_b128 v[96:99], v246 offset:320
    ds_read_b128 v[100:103], v246 offset:11648
    v_mfma_f32_32x32x16_f16 v[128:143], v[60:63], v[108:111], v[128:143]
    v_cvt_pk_bf16_f32 v145, |v114|, |v115|
    v_cvt_pk_bf16_f32 v146, |v116|, |v117|
    v_cvt_pk_bf16_f32 v147, |v118|, |v119|
    v_cvt_pk_bf16_f32 v148, |v120|, |v121|
    v_cvt_pk_bf16_f32 v149, |v122|, |v123|
    v_cvt_pk_bf16_f32 v150, |v124|, |v125|
    v_mfma_f32_16x16x32_f16 v[184:187], v[176:179], v[88:91], 0
    v_cvt_pk_bf16_f32 v151, |v126|, |v127|
    v_exp_f32 v242, v192
    v_mfma_f32_16x16x32_f16 v[184:187], v[180:183], v[92:95], v[184:187]
    v_exp_f32 v243, v193
    v_smfmac_f32_16x16x64_bf16 v[208:211], v[172:175], v[152:159], v250
    v_add_f32 v240, v240, v242
    v_mfma_f32_32x32x16_f16 v[112:127], v[64:67], v[88:91], v[24:39]
    v_pk_mul_f16 v56, v16, v72
    v_pk_mul_f16 v57, v17, v73
    v_pk_mul_f16 v58, v18, v74
    v_pk_mul_f16 v59, v19, v75
    v_cvt_pk_bf16_f32 v152, |v128|, |v129|
    ds_read_b128 v[176:179], v248 offset:320
    ds_read_b128 v[180:183], v248 offset:11648
    v_mfma_f32_32x32x16_f16 v[112:127], v[68:71], v[92:95], v[112:127]
    v_cvt_pk_bf16_f32 v153, |v130|, |v131|
    v_cvt_pk_bf16_f32 v154, |v132|, |v133|
    v_cvt_pk_bf16_f32 v155, |v134|, |v135|
    v_cvt_pk_bf16_f32 v156, |v136|, |v137|
    v_cvt_pk_bf16_f32 v157, |v138|, |v139|
    v_cvt_pk_bf16_f32 v158, |v140|, |v141|
    v_smfmac_f32_16x16x64_bf16 v[184:187], v[160:163], v[144:151], v250
    v_cvt_pk_bf16_f32 v159, |v142|, |v143|
    v_exp_f32 v244, v208
    v_mfma_f32_32x32x16_f16 v[128:143], v[64:67], v[104:107], v[24:39]
    v_pk_mul_f16 v60, v20, v76
    v_pk_mul_f16 v61, v21, v77
    v_pk_mul_f16 v62, v22, v78
    v_pk_mul_f16 v63, v23, v79
    v_cvt_pk_bf16_f32 v144, |v112|, |v113|
    ds_read_b128 v[232:235], v249 offset:320
    ds_read_b128 v[236:239], v249 offset:11648
    v_mfma_f32_32x32x16_f16 v[128:143], v[68:71], v[108:111], v[128:143]
    v_cvt_pk_bf16_f32 v145, |v114|, |v115|
    v_cvt_pk_bf16_f32 v146, |v116|, |v117|
    v_cvt_pk_bf16_f32 v147, |v118|, |v119|
    v_cvt_pk_bf16_f32 v148, |v120|, |v121|
    v_cvt_pk_bf16_f32 v149, |v122|, |v123|
    v_cvt_pk_bf16_f32 v150, |v124|, |v125|
    v_smfmac_f32_16x16x64_bf16 v[212:215], v[160:163], v[152:159], v250
    v_cvt_pk_bf16_f32 v151, |v126|, |v127|
    v_mfma_f32_32x32x16_f16 v[112:127], v[56:59], v[88:91], v[40:55]
    v_pk_mul_f16 v64, v16, v80
    v_pk_mul_f16 v65, v17, v81
    v_pk_mul_f16 v66, v18, v82
    v_exp_f32 v245, v209
    v_cvt_pk_bf16_f32 v152, |v128|, |v129|
    ds_read_b128 v[72:75], v247 offset:320
    ds_read_b128 v[76:79], v247 offset:11648
    v_mfma_f32_32x32x16_f16 v[112:127], v[60:63], v[92:95], v[112:127]
    v_cvt_pk_bf16_f32 v153, |v130|, |v131|
    v_cvt_pk_bf16_f32 v154, |v132|, |v133|
    v_cvt_pk_bf16_f32 v155, |v134|, |v135|
    v_cvt_pk_bf16_f32 v156, |v136|, |v137|
    v_cvt_pk_bf16_f32 v157, |v138|, |v139|
    v_cvt_pk_bf16_f32 v158, |v140|, |v141|
    v_smfmac_f32_16x16x64_bf16 v[184:187], v[168:171], v[144:151], v250
    v_cvt_pk_bf16_f32 v159, |v142|, |v143|
    v_mfma_f32_32x32x16_f16 v[128:143], v[56:59], v[104:107], v[40:55]
    v_pk_mul_f16 v67, v19, v83
    v_pk_mul_f16 v68, v20, v84
    v_pk_mul_f16 v69, v21, v85
    v_pk_mul_f16 v70, v22, v86
    v_pk_mul_f16 v71, v23, v87
    v_cvt_pk_bf16_f32 v144, |v112|, |v113|
    v_mfma_f32_32x32x16_f16 v[128:143], v[60:63], v[108:111], v[128:143]
    v_cvt_pk_bf16_f32 v145, |v114|, |v115|
    v_cvt_pk_bf16_f32 v146, |v116|, |v117|
    v_cvt_pk_bf16_f32 v147, |v118|, |v119|
    v_cvt_pk_bf16_f32 v148, |v120|, |v121|
    v_cvt_pk_bf16_f32 v149, |v122|, |v123|
    v_cvt_pk_bf16_f32 v150, |v124|, |v125|
    v_smfmac_f32_16x16x64_bf16 v[212:215], v[168:171], v[152:159], v250
    v_cvt_pk_bf16_f32 v151, |v126|, |v127|
    s_waitcnt lgkmcnt(2)
    v_mfma_f32_32x32x16_f16 v[216:231], v[232:235], v[104:107], 0
    v_add_f32 v240, v240, v244
    v_fmac_f32 v241, v244, v210
    v_add_f32 v240, v240, v245
    v_fmac_f32 v241, v245, v211
    v_fmac_f32 v241, v242, v194
    v_add_f32 v240, v240, v243
    v_mfma_f32_32x32x16_f16 v[216:231], v[236:239], v[108:111], v[216:231]
    v_fmac_f32 v241, v243, v195
    v_mfma_f32_32x32x16_f16 v[112:127], v[64:67], v[88:91], v[40:55]
    s_waitcnt lgkmcnt(0)
    v_pk_mul_f16 v56, v8, v72
    v_pk_mul_f16 v57, v9, v73
    v_pk_mul_f16 v58, v10, v74
    v_pk_mul_f16 v59, v11, v75
    v_cvt_pk_bf16_f32 v152, |v128|, |v129|
    ds_read_b128 v[80:83], v247 offset:352
    ds_read_b128 v[84:87], v247 offset:11680
    v_mfma_f32_32x32x16_f16 v[112:127], v[68:71], v[92:95], v[112:127]
    v_cvt_pk_bf16_f32 v153, |v130|, |v131|
    v_cvt_pk_bf16_f32 v154, |v132|, |v133|
    v_cvt_pk_bf16_f32 v155, |v134|, |v135|
    v_cvt_pk_bf16_f32 v156, |v136|, |v137|
    v_cvt_pk_bf16_f32 v157, |v138|, |v139|
    v_cvt_pk_bf16_f32 v158, |v140|, |v141|
    v_smfmac_f32_16x16x64_bf16 v[184:187], v[164:167], v[144:151], v250
    v_cvt_pk_bf16_f32 v159, |v142|, |v143|
    v_mfma_f32_32x32x16_f16 v[128:143], v[64:67], v[104:107], v[40:55]
    v_pk_mul_f16 v60, v12, v76
    v_pk_mul_f16 v61, v13, v77
    v_pk_mul_f16 v62, v14, v78
    v_pk_mul_f16 v63, v15, v79
    v_cvt_pk_bf16_f32 v144, |v112|, |v113|
    v_mfma_f32_32x32x16_f16 v[128:143], v[68:71], v[108:111], v[128:143]
    v_cvt_pk_bf16_f32 v145, |v114|, |v115|
    v_cvt_pk_bf16_f32 v146, |v116|, |v117|
    v_cvt_pk_bf16_f32 v147, |v118|, |v119|
    v_cvt_pk_bf16_f32 v148, |v120|, |v121|
    v_cvt_pk_bf16_f32 v149, |v122|, |v123|
    v_cvt_pk_bf16_f32 v150, |v124|, |v125|
    v_smfmac_f32_16x16x64_bf16 v[212:215], v[164:167], v[152:159], v250
    v_cvt_pk_bf16_f32 v151, |v126|, |v127|
    v_mfma_f32_32x32x16_f16 v[112:127], v[56:59], v[96:99], v[24:39]
    s_waitcnt lgkmcnt(0)
    v_pk_mul_f16 v64, v8, v80
    v_pk_mul_f16 v65, v9, v81
    v_pk_mul_f16 v66, v10, v82
    v_pk_mul_f16 v67, v11, v83
    v_pk_mul_f16 v68, v12, v84
    v_cvt_pk_bf16_f32 v152, |v128|, |v129|
    v_mfma_f32_32x32x16_f16 v[112:127], v[60:63], v[100:103], v[112:127]
    v_cvt_pk_bf16_f32 v153, |v130|, |v131|
    v_cvt_pk_bf16_f32 v154, |v132|, |v133|
    v_cvt_pk_bf16_f32 v155, |v134|, |v135|
    v_cvt_pk_bf16_f32 v156, |v136|, |v137|
    v_cvt_pk_bf16_f32 v157, |v138|, |v139|
    v_cvt_pk_bf16_f32 v158, |v140|, |v141|
    v_smfmac_f32_16x16x64_bf16 v[184:187], v[172:175], v[144:151], v250
    v_cvt_pk_bf16_f32 v159, |v142|, |v143|
    v_mfma_f32_32x32x16_f16 v[128:143], v[56:59], v[104:107], v[24:39]
    v_pk_mul_f16 v69, v13, v85
    v_pk_mul_f16 v70, v14, v86
    v_pk_mul_f16 v71, v15, v87
    v_cvt_pk_bf16_f32 v144, |v112|, |v113|
    v_cvt_pk_bf16_f32 v145, |v114|, |v115|
    v_cvt_pk_bf16_f32 v146, |v116|, |v117|
    ds_read_b128 v[88:91], v246 offset:384
    ds_read_b128 v[92:95], v246 offset:11712
    v_mfma_f32_32x32x16_f16 v[128:143], v[60:63], v[108:111], v[128:143]
    v_cvt_pk_bf16_f32 v147, |v118|, |v119|
    v_cvt_pk_bf16_f32 v148, |v120|, |v121|
    v_cvt_pk_bf16_f32 v149, |v122|, |v123|
    v_cvt_pk_bf16_f32 v150, |v124|, |v125|
    v_cvt_pk_bf16_f32 v151, |v126|, |v127|
    v_exp_f32 v242, v184
    v_mfma_f32_16x16x32_f16 v[192:195], v[176:179], v[96:99], 0
    v_exp_f32 v243, v185
    v_mfma_f32_16x16x32_f16 v[192:195], v[180:183], v[100:103], v[192:195]
    v_add_f32 v240, v240, v242
    v_smfmac_f32_16x16x64_bf16 v[212:215], v[172:175], v[152:159], v250
    v_mfma_f32_32x32x16_f16 v[112:127], v[64:67], v[96:99], v[24:39]
    v_pk_mul_f16 v56, v16, v72
    v_pk_mul_f16 v57, v17, v73
    v_pk_mul_f16 v58, v18, v74
    v_pk_mul_f16 v59, v19, v75
    v_cvt_pk_bf16_f32 v152, |v128|, |v129|
    v_cvt_pk_bf16_f32 v153, |v130|, |v131|
    ds_read_b128 v[176:179], v248 offset:384
    ds_read_b128 v[180:183], v248 offset:11712
    v_mfma_f32_32x32x16_f16 v[112:127], v[68:71], v[100:103], v[112:127]
    v_cvt_pk_bf16_f32 v154, |v132|, |v133|
    v_cvt_pk_bf16_f32 v155, |v134|, |v135|
    v_cvt_pk_bf16_f32 v156, |v136|, |v137|
    v_cvt_pk_bf16_f32 v157, |v138|, |v139|
    v_cvt_pk_bf16_f32 v158, |v140|, |v141|
    v_cvt_pk_bf16_f32 v159, |v142|, |v143|
    v_smfmac_f32_16x16x64_bf16 v[192:195], v[160:163], v[144:151], v250
    v_exp_f32 v244, v212
    v_mfma_f32_32x32x16_f16 v[128:143], v[64:67], v[104:107], v[24:39]
    v_pk_mul_f16 v60, v20, v76
    v_pk_mul_f16 v61, v21, v77
    v_pk_mul_f16 v62, v22, v78
    v_pk_mul_f16 v63, v23, v79
    v_add_f32 v240, v240, v244
    v_cvt_pk_bf16_f32 v144, |v112|, |v113|
    v_mfma_f32_32x32x16_f16 v[128:143], v[68:71], v[108:111], v[128:143]
    v_cvt_pk_bf16_f32 v145, |v114|, |v115|
    v_cvt_pk_bf16_f32 v146, |v116|, |v117|
    v_cvt_pk_bf16_f32 v147, |v118|, |v119|
    v_cvt_pk_bf16_f32 v148, |v120|, |v121|
    v_cvt_pk_bf16_f32 v149, |v122|, |v123|
    v_cvt_pk_bf16_f32 v150, |v124|, |v125|
    v_smfmac_f32_16x16x64_bf16 v[216:219], v[160:163], v[152:159], v250
    v_cvt_pk_bf16_f32 v151, |v126|, |v127|
    v_mfma_f32_32x32x16_f16 v[112:127], v[56:59], v[96:99], v[40:55]
    v_pk_mul_f16 v64, v16, v80
    v_pk_mul_f16 v65, v17, v81
    v_pk_mul_f16 v66, v18, v82
    v_exp_f32 v245, v213
    v_cvt_pk_bf16_f32 v152, |v128|, |v129|
    ds_read_b128 v[72:75], v247 offset:384
    ds_read_b128 v[76:79], v247 offset:11712
    v_mfma_f32_32x32x16_f16 v[112:127], v[60:63], v[100:103], v[112:127]
    v_cvt_pk_bf16_f32 v153, |v130|, |v131|
    v_cvt_pk_bf16_f32 v154, |v132|, |v133|
    v_cvt_pk_bf16_f32 v155, |v134|, |v135|
    v_cvt_pk_bf16_f32 v156, |v136|, |v137|
    v_cvt_pk_bf16_f32 v157, |v138|, |v139|
    v_cvt_pk_bf16_f32 v158, |v140|, |v141|
    v_smfmac_f32_16x16x64_bf16 v[192:195], v[168:171], v[144:151], v250
    v_cvt_pk_bf16_f32 v159, |v142|, |v143|
    v_fmac_f32 v241, v244, v214
    v_mfma_f32_32x32x16_f16 v[128:143], v[56:59], v[104:107], v[40:55]
    v_pk_mul_f16 v67, v19, v83
    v_pk_mul_f16 v68, v20, v84
    v_pk_mul_f16 v69, v21, v85
    v_pk_mul_f16 v70, v22, v86
    v_pk_mul_f16 v71, v23, v87
    v_cvt_pk_bf16_f32 v144, |v112|, |v113|
    v_mfma_f32_32x32x16_f16 v[128:143], v[60:63], v[108:111], v[128:143]
    v_cvt_pk_bf16_f32 v145, |v114|, |v115|
    v_cvt_pk_bf16_f32 v146, |v116|, |v117|
    v_cvt_pk_bf16_f32 v147, |v118|, |v119|
    v_cvt_pk_bf16_f32 v148, |v120|, |v121|
    v_cvt_pk_bf16_f32 v149, |v122|, |v123|
    v_cvt_pk_bf16_f32 v150, |v124|, |v125|
    v_smfmac_f32_16x16x64_bf16 v[216:219], v[168:171], v[152:159], v250
    v_cvt_pk_bf16_f32 v151, |v126|, |v127|
    v_add_f32 v240, v240, v245
    v_mfma_f32_32x32x16_f16 v[112:127], v[64:67], v[96:99], v[40:55]
    s_waitcnt lgkmcnt(0)
    v_pk_mul_f16 v56, v8, v72
    v_pk_mul_f16 v57, v9, v73
    v_pk_mul_f16 v58, v10, v74
    v_pk_mul_f16 v59, v11, v75
    v_fmac_f32 v241, v242, v186
    v_cvt_pk_bf16_f32 v152, |v128|, |v129|
    ds_read_b128 v[80:83], v247 offset:416
    ds_read_b128 v[84:87], v247 offset:11744
    v_mfma_f32_32x32x16_f16 v[112:127], v[68:71], v[100:103], v[112:127]
    v_cvt_pk_bf16_f32 v153, |v130|, |v131|
    v_cvt_pk_bf16_f32 v154, |v132|, |v133|
    v_cvt_pk_bf16_f32 v155, |v134|, |v135|
    v_cvt_pk_bf16_f32 v156, |v136|, |v137|
    v_cvt_pk_bf16_f32 v157, |v138|, |v139|
    v_cvt_pk_bf16_f32 v158, |v140|, |v141|
    v_smfmac_f32_16x16x64_bf16 v[192:195], v[164:167], v[144:151], v250
    v_cvt_pk_bf16_f32 v159, |v142|, |v143|
    v_fmac_f32 v241, v245, v215
    v_mfma_f32_32x32x16_f16 v[128:143], v[64:67], v[104:107], v[40:55]
    v_pk_mul_f16 v60, v12, v76
    v_pk_mul_f16 v61, v13, v77
    v_pk_mul_f16 v62, v14, v78
    v_pk_mul_f16 v63, v15, v79
    v_add_f32 v240, v240, v243
    v_cvt_pk_bf16_f32 v144, |v112|, |v113|
    v_mfma_f32_32x32x16_f16 v[128:143], v[68:71], v[108:111], v[128:143]
    v_cvt_pk_bf16_f32 v145, |v114|, |v115|
    v_cvt_pk_bf16_f32 v146, |v116|, |v117|
    v_cvt_pk_bf16_f32 v147, |v118|, |v119|
    v_cvt_pk_bf16_f32 v148, |v120|, |v121|
    v_cvt_pk_bf16_f32 v149, |v122|, |v123|
    v_cvt_pk_bf16_f32 v150, |v124|, |v125|
    v_smfmac_f32_16x16x64_bf16 v[216:219], v[164:167], v[152:159], v250
    v_cvt_pk_bf16_f32 v151, |v126|, |v127|
    v_fmac_f32 v241, v243, v187
    v_mfma_f32_32x32x16_f16 v[112:127], v[56:59], v[88:91], v[24:39]
    s_waitcnt lgkmcnt(0)
    v_pk_mul_f16 v64, v8, v80
    v_pk_mul_f16 v65, v9, v81
    v_pk_mul_f16 v66, v10, v82
    v_pk_mul_f16 v67, v11, v83
    v_pk_mul_f16 v68, v12, v84
    v_cvt_pk_bf16_f32 v152, |v128|, |v129|
    v_mfma_f32_32x32x16_f16 v[112:127], v[60:63], v[92:95], v[112:127]
    v_cvt_pk_bf16_f32 v153, |v130|, |v131|
    v_cvt_pk_bf16_f32 v154, |v132|, |v133|
    v_cvt_pk_bf16_f32 v155, |v134|, |v135|
    v_cvt_pk_bf16_f32 v156, |v136|, |v137|
    v_cvt_pk_bf16_f32 v157, |v138|, |v139|
    v_cvt_pk_bf16_f32 v158, |v140|, |v141|
    v_smfmac_f32_16x16x64_bf16 v[192:195], v[172:175], v[144:151], v250
    v_cvt_pk_bf16_f32 v159, |v142|, |v143|
    v_mfma_f32_32x32x16_f16 v[128:143], v[56:59], v[104:107], v[24:39]
    v_pk_mul_f16 v69, v13, v85
    v_pk_mul_f16 v70, v14, v86
    v_pk_mul_f16 v71, v15, v87
    v_cvt_pk_bf16_f32 v144, |v112|, |v113|
    v_cvt_pk_bf16_f32 v145, |v114|, |v115|
    v_cvt_pk_bf16_f32 v146, |v116|, |v117|
    ds_read_b128 v[96:99], v246 offset:448
    ds_read_b128 v[100:103], v246 offset:11776
    v_mfma_f32_32x32x16_f16 v[128:143], v[60:63], v[108:111], v[128:143]
    v_cvt_pk_bf16_f32 v147, |v118|, |v119|
    v_cvt_pk_bf16_f32 v148, |v120|, |v121|
    v_cvt_pk_bf16_f32 v149, |v122|, |v123|
    v_cvt_pk_bf16_f32 v150, |v124|, |v125|
    v_cvt_pk_bf16_f32 v151, |v126|, |v127|
    v_exp_f32 v242, v192
    v_mfma_f32_16x16x32_f16 v[184:187], v[176:179], v[88:91], 0
    v_exp_f32 v243, v193
    v_mfma_f32_16x16x32_f16 v[184:187], v[180:183], v[92:95], v[184:187]
    v_add_f32 v240, v240, v242
    v_smfmac_f32_16x16x64_bf16 v[216:219], v[172:175], v[152:159], v250
    v_mfma_f32_32x32x16_f16 v[112:127], v[64:67], v[88:91], v[24:39]
    v_pk_mul_f16 v56, v16, v72
    v_pk_mul_f16 v57, v17, v73
    v_pk_mul_f16 v58, v18, v74
    v_pk_mul_f16 v59, v19, v75
    v_cvt_pk_bf16_f32 v152, |v128|, |v129|
    v_cvt_pk_bf16_f32 v153, |v130|, |v131|
    ds_read_b128 v[176:179], v248 offset:448
    ds_read_b128 v[180:183], v248 offset:11776
    v_mfma_f32_32x32x16_f16 v[112:127], v[68:71], v[92:95], v[112:127]
    v_cvt_pk_bf16_f32 v154, |v132|, |v133|
    v_cvt_pk_bf16_f32 v155, |v134|, |v135|
    v_cvt_pk_bf16_f32 v156, |v136|, |v137|
    v_cvt_pk_bf16_f32 v157, |v138|, |v139|
    v_cvt_pk_bf16_f32 v158, |v140|, |v141|
    v_cvt_pk_bf16_f32 v159, |v142|, |v143|
    v_smfmac_f32_16x16x64_bf16 v[184:187], v[160:163], v[144:151], v250
    v_exp_f32 v244, v216
    v_mfma_f32_32x32x16_f16 v[128:143], v[64:67], v[104:107], v[24:39]
    v_pk_mul_f16 v60, v20, v76
    v_pk_mul_f16 v61, v21, v77
    v_pk_mul_f16 v62, v22, v78
    v_pk_mul_f16 v63, v23, v79
    v_add_f32 v240, v240, v244
    v_cvt_pk_bf16_f32 v144, |v112|, |v113|
    v_mfma_f32_32x32x16_f16 v[128:143], v[68:71], v[108:111], v[128:143]
    v_cvt_pk_bf16_f32 v145, |v114|, |v115|
    v_cvt_pk_bf16_f32 v146, |v116|, |v117|
    v_cvt_pk_bf16_f32 v147, |v118|, |v119|
    v_cvt_pk_bf16_f32 v148, |v120|, |v121|
    v_cvt_pk_bf16_f32 v149, |v122|, |v123|
    v_cvt_pk_bf16_f32 v150, |v124|, |v125|
    v_smfmac_f32_16x16x64_bf16 v[220:223], v[160:163], v[152:159], v250
    v_cvt_pk_bf16_f32 v151, |v126|, |v127|
    v_mfma_f32_32x32x16_f16 v[112:127], v[56:59], v[88:91], v[40:55]
    v_pk_mul_f16 v64, v16, v80
    v_pk_mul_f16 v65, v17, v81
    v_pk_mul_f16 v66, v18, v82
    v_exp_f32 v245, v217
    v_cvt_pk_bf16_f32 v152, |v128|, |v129|
    ds_read_b128 v[72:75], v247 offset:448
    ds_read_b128 v[76:79], v247 offset:11776
    v_mfma_f32_32x32x16_f16 v[112:127], v[60:63], v[92:95], v[112:127]
    v_cvt_pk_bf16_f32 v153, |v130|, |v131|
    v_cvt_pk_bf16_f32 v154, |v132|, |v133|
    v_cvt_pk_bf16_f32 v155, |v134|, |v135|
    v_cvt_pk_bf16_f32 v156, |v136|, |v137|
    v_cvt_pk_bf16_f32 v157, |v138|, |v139|
    v_cvt_pk_bf16_f32 v158, |v140|, |v141|
    v_smfmac_f32_16x16x64_bf16 v[184:187], v[168:171], v[144:151], v250
    v_cvt_pk_bf16_f32 v159, |v142|, |v143|
    v_fmac_f32 v241, v244, v218
    v_mfma_f32_32x32x16_f16 v[128:143], v[56:59], v[104:107], v[40:55]
    v_pk_mul_f16 v67, v19, v83
    v_pk_mul_f16 v68, v20, v84
    v_pk_mul_f16 v69, v21, v85
    v_pk_mul_f16 v70, v22, v86
    v_pk_mul_f16 v71, v23, v87
    v_cvt_pk_bf16_f32 v144, |v112|, |v113|
    v_mfma_f32_32x32x16_f16 v[128:143], v[60:63], v[108:111], v[128:143]
    v_cvt_pk_bf16_f32 v145, |v114|, |v115|
    v_cvt_pk_bf16_f32 v146, |v116|, |v117|
    v_cvt_pk_bf16_f32 v147, |v118|, |v119|
    v_cvt_pk_bf16_f32 v148, |v120|, |v121|
    v_cvt_pk_bf16_f32 v149, |v122|, |v123|
    v_cvt_pk_bf16_f32 v150, |v124|, |v125|
    v_smfmac_f32_16x16x64_bf16 v[220:223], v[168:171], v[152:159], v250
    v_cvt_pk_bf16_f32 v151, |v126|, |v127|
    v_add_f32 v240, v240, v245
    v_mfma_f32_32x32x16_f16 v[112:127], v[64:67], v[88:91], v[40:55]
    s_waitcnt lgkmcnt(0)
    v_pk_mul_f16 v56, v8, v72
    v_pk_mul_f16 v57, v9, v73
    v_pk_mul_f16 v58, v10, v74
    v_pk_mul_f16 v59, v11, v75
    v_fmac_f32 v241, v242, v194
    v_cvt_pk_bf16_f32 v152, |v128|, |v129|
    ds_read_b128 v[80:83], v247 offset:480
    ds_read_b128 v[84:87], v247 offset:11808
    v_mfma_f32_32x32x16_f16 v[112:127], v[68:71], v[92:95], v[112:127]
    v_cvt_pk_bf16_f32 v153, |v130|, |v131|
    v_cvt_pk_bf16_f32 v154, |v132|, |v133|
    v_cvt_pk_bf16_f32 v155, |v134|, |v135|
    v_cvt_pk_bf16_f32 v156, |v136|, |v137|
    v_cvt_pk_bf16_f32 v157, |v138|, |v139|
    v_cvt_pk_bf16_f32 v158, |v140|, |v141|
    v_smfmac_f32_16x16x64_bf16 v[184:187], v[164:167], v[144:151], v250
    v_cvt_pk_bf16_f32 v159, |v142|, |v143|
    v_fmac_f32 v241, v245, v219
    v_mfma_f32_32x32x16_f16 v[128:143], v[64:67], v[104:107], v[40:55]
    v_pk_mul_f16 v60, v12, v76
    v_pk_mul_f16 v61, v13, v77
    v_pk_mul_f16 v62, v14, v78
    v_pk_mul_f16 v63, v15, v79
    v_add_f32 v240, v240, v243
    v_cvt_pk_bf16_f32 v144, |v112|, |v113|
    v_mfma_f32_32x32x16_f16 v[128:143], v[68:71], v[108:111], v[128:143]
    v_cvt_pk_bf16_f32 v145, |v114|, |v115|
    v_cvt_pk_bf16_f32 v146, |v116|, |v117|
    v_cvt_pk_bf16_f32 v147, |v118|, |v119|
    v_cvt_pk_bf16_f32 v148, |v120|, |v121|
    v_cvt_pk_bf16_f32 v149, |v122|, |v123|
    v_cvt_pk_bf16_f32 v150, |v124|, |v125|
    v_smfmac_f32_16x16x64_bf16 v[220:223], v[164:167], v[152:159], v250
    v_cvt_pk_bf16_f32 v151, |v126|, |v127|
    v_fmac_f32 v241, v243, v195
    s_setprio 0
    v_mfma_f32_32x32x16_f16 v[112:127], v[56:59], v[96:99], v[24:39]
    s_waitcnt lgkmcnt(0)
    v_pk_mul_f16 v64, v8, v80
    v_pk_mul_f16 v65, v9, v81
    v_pk_mul_f16 v66, v10, v82
    v_pk_mul_f16 v67, v11, v83
    v_pk_mul_f16 v68, v12, v84
    v_cvt_pk_bf16_f32 v152, |v128|, |v129|
    v_mfma_f32_32x32x16_f16 v[112:127], v[60:63], v[100:103], v[112:127]
    v_cvt_pk_bf16_f32 v153, |v130|, |v131|
    v_cvt_pk_bf16_f32 v154, |v132|, |v133|
    v_cvt_pk_bf16_f32 v155, |v134|, |v135|
    v_cvt_pk_bf16_f32 v156, |v136|, |v137|
    v_cvt_pk_bf16_f32 v157, |v138|, |v139|
    v_cvt_pk_bf16_f32 v158, |v140|, |v141|
    v_smfmac_f32_16x16x64_bf16 v[184:187], v[172:175], v[144:151], v250
    v_cvt_pk_bf16_f32 v159, |v142|, |v143|
    v_mfma_f32_32x32x16_f16 v[128:143], v[56:59], v[104:107], v[24:39]
    v_pk_mul_f16 v69, v13, v85
    v_pk_mul_f16 v70, v14, v86
    v_pk_mul_f16 v71, v15, v87
    v_cvt_pk_bf16_f32 v144, |v112|, |v113|
    v_cvt_pk_bf16_f32 v145, |v114|, |v115|
    v_cvt_pk_bf16_f32 v146, |v116|, |v117|
    ds_read_b128 v[88:91], v246 offset:512
    ds_read_b128 v[92:95], v246 offset:11840
    v_mfma_f32_32x32x16_f16 v[128:143], v[60:63], v[108:111], v[128:143]
    v_cvt_pk_bf16_f32 v147, |v118|, |v119|
    v_cvt_pk_bf16_f32 v148, |v120|, |v121|
    v_cvt_pk_bf16_f32 v149, |v122|, |v123|
    v_cvt_pk_bf16_f32 v150, |v124|, |v125|
    v_cvt_pk_bf16_f32 v151, |v126|, |v127|
    v_exp_f32 v242, v184
    v_mfma_f32_16x16x32_f16 v[192:195], v[176:179], v[96:99], 0
    v_exp_f32 v243, v185
    v_mfma_f32_16x16x32_f16 v[192:195], v[180:183], v[100:103], v[192:195]
    v_add_f32 v240, v240, v242
    v_smfmac_f32_16x16x64_bf16 v[220:223], v[172:175], v[152:159], v250
    v_mfma_f32_32x32x16_f16 v[112:127], v[64:67], v[96:99], v[24:39]
    v_pk_mul_f16 v56, v16, v72
    v_pk_mul_f16 v57, v17, v73
    v_pk_mul_f16 v58, v18, v74
    v_pk_mul_f16 v59, v19, v75
    v_cvt_pk_bf16_f32 v152, |v128|, |v129|
    v_cvt_pk_bf16_f32 v153, |v130|, |v131|
    ds_read_b128 v[176:179], v248 offset:512
    ds_read_b128 v[180:183], v248 offset:11840
    v_mfma_f32_32x32x16_f16 v[112:127], v[68:71], v[100:103], v[112:127]
    v_cvt_pk_bf16_f32 v154, |v132|, |v133|
    v_cvt_pk_bf16_f32 v155, |v134|, |v135|
    v_cvt_pk_bf16_f32 v156, |v136|, |v137|
    v_cvt_pk_bf16_f32 v157, |v138|, |v139|
    v_cvt_pk_bf16_f32 v158, |v140|, |v141|
    v_cvt_pk_bf16_f32 v159, |v142|, |v143|
    v_smfmac_f32_16x16x64_bf16 v[192:195], v[160:163], v[144:151], v250
    v_exp_f32 v244, v220
    v_mfma_f32_32x32x16_f16 v[128:143], v[64:67], v[104:107], v[24:39]
    v_pk_mul_f16 v60, v20, v76
    v_pk_mul_f16 v61, v21, v77
    v_pk_mul_f16 v62, v22, v78
    v_pk_mul_f16 v63, v23, v79
    v_add_f32 v240, v240, v244
    v_cvt_pk_bf16_f32 v144, |v112|, |v113|
    v_mfma_f32_32x32x16_f16 v[128:143], v[68:71], v[108:111], v[128:143]
    v_cvt_pk_bf16_f32 v145, |v114|, |v115|
    v_cvt_pk_bf16_f32 v146, |v116|, |v117|
    v_cvt_pk_bf16_f32 v147, |v118|, |v119|
    v_cvt_pk_bf16_f32 v148, |v120|, |v121|
    v_cvt_pk_bf16_f32 v149, |v122|, |v123|
    v_cvt_pk_bf16_f32 v150, |v124|, |v125|
    v_smfmac_f32_16x16x64_bf16 v[224:227], v[160:163], v[152:159], v250
    v_cvt_pk_bf16_f32 v151, |v126|, |v127|
    v_mfma_f32_32x32x16_f16 v[112:127], v[56:59], v[96:99], v[40:55]
    v_pk_mul_f16 v64, v16, v80
    v_pk_mul_f16 v65, v17, v81
    v_pk_mul_f16 v66, v18, v82
    v_exp_f32 v245, v221
    v_cvt_pk_bf16_f32 v152, |v128|, |v129|
    ds_read_b128 v[72:75], v247 offset:512
    ds_read_b128 v[76:79], v247 offset:11840
    v_mfma_f32_32x32x16_f16 v[112:127], v[60:63], v[100:103], v[112:127]
    v_cvt_pk_bf16_f32 v153, |v130|, |v131|
    v_cvt_pk_bf16_f32 v154, |v132|, |v133|
    v_cvt_pk_bf16_f32 v155, |v134|, |v135|
    v_cvt_pk_bf16_f32 v156, |v136|, |v137|
    v_cvt_pk_bf16_f32 v157, |v138|, |v139|
    v_cvt_pk_bf16_f32 v158, |v140|, |v141|
    v_smfmac_f32_16x16x64_bf16 v[192:195], v[168:171], v[144:151], v250
    v_cvt_pk_bf16_f32 v159, |v142|, |v143|
    v_fmac_f32 v241, v244, v222
    v_mfma_f32_32x32x16_f16 v[128:143], v[56:59], v[104:107], v[40:55]
    v_pk_mul_f16 v67, v19, v83
    v_pk_mul_f16 v68, v20, v84
    v_pk_mul_f16 v69, v21, v85
    v_pk_mul_f16 v70, v22, v86
    v_pk_mul_f16 v71, v23, v87
    v_cvt_pk_bf16_f32 v144, |v112|, |v113|
    v_mfma_f32_32x32x16_f16 v[128:143], v[60:63], v[108:111], v[128:143]
    v_cvt_pk_bf16_f32 v145, |v114|, |v115|
    v_cvt_pk_bf16_f32 v146, |v116|, |v117|
    v_cvt_pk_bf16_f32 v147, |v118|, |v119|
    v_cvt_pk_bf16_f32 v148, |v120|, |v121|
    v_cvt_pk_bf16_f32 v149, |v122|, |v123|
    v_cvt_pk_bf16_f32 v150, |v124|, |v125|
    v_smfmac_f32_16x16x64_bf16 v[224:227], v[168:171], v[152:159], v250
    v_cvt_pk_bf16_f32 v151, |v126|, |v127|
    v_add_f32 v240, v240, v245
    v_mfma_f32_32x32x16_f16 v[112:127], v[64:67], v[96:99], v[40:55]
    s_waitcnt lgkmcnt(0)
    v_pk_mul_f16 v56, v8, v72
    v_pk_mul_f16 v57, v9, v73
    v_pk_mul_f16 v58, v10, v74
    v_pk_mul_f16 v59, v11, v75
    v_fmac_f32 v241, v242, v186
    v_cvt_pk_bf16_f32 v152, |v128|, |v129|
    ds_read_b128 v[80:83], v247 offset:544
    ds_read_b128 v[84:87], v247 offset:11872
    v_mfma_f32_32x32x16_f16 v[112:127], v[68:71], v[100:103], v[112:127]
    v_cvt_pk_bf16_f32 v153, |v130|, |v131|
    v_cvt_pk_bf16_f32 v154, |v132|, |v133|
    v_cvt_pk_bf16_f32 v155, |v134|, |v135|
    v_cvt_pk_bf16_f32 v156, |v136|, |v137|
    v_cvt_pk_bf16_f32 v157, |v138|, |v139|
    v_cvt_pk_bf16_f32 v158, |v140|, |v141|
    v_smfmac_f32_16x16x64_bf16 v[192:195], v[164:167], v[144:151], v250
    v_cvt_pk_bf16_f32 v159, |v142|, |v143|
    v_fmac_f32 v241, v245, v223
    v_mfma_f32_32x32x16_f16 v[128:143], v[64:67], v[104:107], v[40:55]
    v_pk_mul_f16 v60, v12, v76
    v_pk_mul_f16 v61, v13, v77
    v_pk_mul_f16 v62, v14, v78
    v_pk_mul_f16 v63, v15, v79
    v_add_f32 v240, v240, v243
    v_cvt_pk_bf16_f32 v144, |v112|, |v113|
    v_mfma_f32_32x32x16_f16 v[128:143], v[68:71], v[108:111], v[128:143]
    v_cvt_pk_bf16_f32 v145, |v114|, |v115|
    v_cvt_pk_bf16_f32 v146, |v116|, |v117|
    v_cvt_pk_bf16_f32 v147, |v118|, |v119|
    v_cvt_pk_bf16_f32 v148, |v120|, |v121|
    v_cvt_pk_bf16_f32 v149, |v122|, |v123|
    v_cvt_pk_bf16_f32 v150, |v124|, |v125|
    v_smfmac_f32_16x16x64_bf16 v[224:227], v[164:167], v[152:159], v250
    v_cvt_pk_bf16_f32 v151, |v126|, |v127|
    v_fmac_f32 v241, v243, v187
    v_mfma_f32_32x32x16_f16 v[112:127], v[56:59], v[88:91], v[24:39]
    s_waitcnt lgkmcnt(0)
    v_pk_mul_f16 v64, v8, v80
    v_pk_mul_f16 v65, v9, v81
    v_pk_mul_f16 v66, v10, v82
    v_pk_mul_f16 v67, v11, v83
    v_pk_mul_f16 v68, v12, v84
    v_cvt_pk_bf16_f32 v152, |v128|, |v129|
    v_mfma_f32_32x32x16_f16 v[112:127], v[60:63], v[92:95], v[112:127]
    v_cvt_pk_bf16_f32 v153, |v130|, |v131|
    v_cvt_pk_bf16_f32 v154, |v132|, |v133|
    v_cvt_pk_bf16_f32 v155, |v134|, |v135|
    v_cvt_pk_bf16_f32 v156, |v136|, |v137|
    v_cvt_pk_bf16_f32 v157, |v138|, |v139|
    v_cvt_pk_bf16_f32 v158, |v140|, |v141|
    v_smfmac_f32_16x16x64_bf16 v[192:195], v[172:175], v[144:151], v250
    v_cvt_pk_bf16_f32 v159, |v142|, |v143|
    v_mfma_f32_32x32x16_f16 v[128:143], v[56:59], v[104:107], v[24:39]
    v_pk_mul_f16 v69, v13, v85
    v_pk_mul_f16 v70, v14, v86
    v_pk_mul_f16 v71, v15, v87
    v_mfma_f32_32x32x16_f16 v[128:143], v[60:63], v[108:111], v[128:143]
    v_cvt_pk_bf16_f32 v144, |v112|, |v113|
    v_cvt_pk_bf16_f32 v145, |v114|, |v115|
    v_cvt_pk_bf16_f32 v146, |v116|, |v117|
    v_cvt_pk_bf16_f32 v147, |v118|, |v119|
    v_cvt_pk_bf16_f32 v148, |v120|, |v121|
    v_cvt_pk_bf16_f32 v149, |v122|, |v123|
    v_mfma_f32_16x16x32_f16 v[184:187], v[176:179], v[88:91], 0
    v_cvt_pk_bf16_f32 v150, |v124|, |v125|
    v_cvt_pk_bf16_f32 v151, |v126|, |v127|
    v_mfma_f32_16x16x32_f16 v[184:187], v[180:183], v[92:95], v[184:187]
    v_exp_f32 v242, v192
    v_smfmac_f32_16x16x64_bf16 v[224:227], v[172:175], v[152:159], v250
    v_exp_f32 v243, v193
    v_add_f32 v240, v240, v242
    v_mfma_f32_32x32x16_f16 v[112:127], v[64:67], v[88:91], v[24:39]
    v_pk_mul_f16 v56, v16, v72
    v_pk_mul_f16 v57, v17, v73
    v_pk_mul_f16 v58, v18, v74
    v_pk_mul_f16 v59, v19, v75
    v_mfma_f32_32x32x16_f16 v[112:127], v[68:71], v[92:95], v[112:127]
    v_cvt_pk_bf16_f32 v152, |v128|, |v129|
    v_cvt_pk_bf16_f32 v153, |v130|, |v131|
    v_cvt_pk_bf16_f32 v154, |v132|, |v133|
    v_cvt_pk_bf16_f32 v155, |v134|, |v135|
    v_cvt_pk_bf16_f32 v156, |v136|, |v137|
    v_cvt_pk_bf16_f32 v157, |v138|, |v139|
    v_smfmac_f32_16x16x64_bf16 v[184:187], v[160:163], v[144:151], v250
    v_cvt_pk_bf16_f32 v158, |v140|, |v141|
    v_cvt_pk_bf16_f32 v159, |v142|, |v143|
    v_exp_f32 v244, v224
    v_mfma_f32_32x32x16_f16 v[128:143], v[64:67], v[104:107], v[24:39]
    v_pk_mul_f16 v60, v20, v76
    v_pk_mul_f16 v61, v21, v77
    v_pk_mul_f16 v62, v22, v78
    v_pk_mul_f16 v63, v23, v79
    v_add_f32 v240, v240, v244
    v_cvt_pk_bf16_f32 v144, |v112|, |v113|
    v_mfma_f32_32x32x16_f16 v[128:143], v[68:71], v[108:111], v[128:143]
    v_cvt_pk_bf16_f32 v145, |v114|, |v115|
    v_cvt_pk_bf16_f32 v146, |v116|, |v117|
    v_cvt_pk_bf16_f32 v147, |v118|, |v119|
    v_cvt_pk_bf16_f32 v148, |v120|, |v121|
    v_cvt_pk_bf16_f32 v149, |v122|, |v123|
    v_cvt_pk_bf16_f32 v150, |v124|, |v125|
    v_smfmac_f32_16x16x64_bf16 v[228:231], v[160:163], v[152:159], v250
    v_cvt_pk_bf16_f32 v151, |v126|, |v127|
    v_mfma_f32_32x32x16_f16 v[112:127], v[56:59], v[88:91], v[40:55]
    v_pk_mul_f16 v64, v16, v80
    v_pk_mul_f16 v65, v17, v81
    v_pk_mul_f16 v66, v18, v82
    v_exp_f32 v245, v225
    v_cvt_pk_bf16_f32 v152, |v128|, |v129|
    v_mfma_f32_32x32x16_f16 v[112:127], v[60:63], v[92:95], v[112:127]
    v_cvt_pk_bf16_f32 v153, |v130|, |v131|
    v_cvt_pk_bf16_f32 v154, |v132|, |v133|
    v_cvt_pk_bf16_f32 v155, |v134|, |v135|
    v_cvt_pk_bf16_f32 v156, |v136|, |v137|
    v_cvt_pk_bf16_f32 v157, |v138|, |v139|
    v_cvt_pk_bf16_f32 v158, |v140|, |v141|
    v_smfmac_f32_16x16x64_bf16 v[184:187], v[168:171], v[144:151], v250
    v_cvt_pk_bf16_f32 v159, |v142|, |v143|
    v_fmac_f32 v241, v244, v226
    v_mfma_f32_32x32x16_f16 v[128:143], v[56:59], v[104:107], v[40:55]
    v_pk_mul_f16 v67, v19, v83
    v_pk_mul_f16 v68, v20, v84
    v_pk_mul_f16 v69, v21, v85
    v_pk_mul_f16 v70, v22, v86
    v_pk_mul_f16 v71, v23, v87
    v_cvt_pk_bf16_f32 v144, |v112|, |v113|
    v_mfma_f32_32x32x16_f16 v[128:143], v[60:63], v[108:111], v[128:143]
    v_cvt_pk_bf16_f32 v145, |v114|, |v115|
    v_cvt_pk_bf16_f32 v146, |v116|, |v117|
    v_cvt_pk_bf16_f32 v147, |v118|, |v119|
    v_cvt_pk_bf16_f32 v148, |v120|, |v121|
    v_cvt_pk_bf16_f32 v149, |v122|, |v123|
    v_cvt_pk_bf16_f32 v150, |v124|, |v125|
    v_smfmac_f32_16x16x64_bf16 v[228:231], v[168:171], v[152:159], v250
    v_cvt_pk_bf16_f32 v151, |v126|, |v127|
    v_add_f32 v240, v240, v245
    v_mfma_f32_32x32x16_f16 v[112:127], v[64:67], v[88:91], v[40:55]
    v_fmac_f32 v241, v242, v194
    v_mfma_f32_32x32x16_f16 v[112:127], v[68:71], v[92:95], v[112:127]
    v_cvt_pk_bf16_f32 v152, |v128|, |v129|
    v_cvt_pk_bf16_f32 v153, |v130|, |v131|
    v_cvt_pk_bf16_f32 v154, |v132|, |v133|
    v_cvt_pk_bf16_f32 v155, |v134|, |v135|
    v_cvt_pk_bf16_f32 v156, |v136|, |v137|
    v_cvt_pk_bf16_f32 v157, |v138|, |v139|
    v_smfmac_f32_16x16x64_bf16 v[184:187], v[164:167], v[144:151], v250
    v_cvt_pk_bf16_f32 v158, |v140|, |v141|
    v_cvt_pk_bf16_f32 v159, |v142|, |v143|
    v_fmac_f32 v241, v245, v227
    v_mfma_f32_32x32x16_f16 v[128:143], v[64:67], v[104:107], v[40:55]
    v_add_f32 v240, v240, v243
    v_mfma_f32_32x32x16_f16 v[128:143], v[68:71], v[108:111], v[128:143]
    v_cvt_pk_bf16_f32 v144, |v112|, |v113|
    v_cvt_pk_bf16_f32 v145, |v114|, |v115|
    v_cvt_pk_bf16_f32 v146, |v116|, |v117|
    v_cvt_pk_bf16_f32 v147, |v118|, |v119|
    v_cvt_pk_bf16_f32 v148, |v120|, |v121|
    v_cvt_pk_bf16_f32 v149, |v122|, |v123|
    v_smfmac_f32_16x16x64_bf16 v[228:231], v[164:167], v[152:159], v250
    v_cvt_pk_bf16_f32 v150, |v124|, |v125|
    v_cvt_pk_bf16_f32 v151, |v126|, |v127|
    v_fmac_f32 v241, v243, v195
    s_nop 0
    v_smfmac_f32_16x16x64_bf16 v[184:187], v[172:175], v[144:151], v250
    v_cvt_pk_bf16_f32 v152, |v128|, |v129|
    v_cvt_pk_bf16_f32 v153, |v130|, |v131|
    v_cvt_pk_bf16_f32 v154, |v132|, |v133|
    v_cvt_pk_bf16_f32 v155, |v134|, |v135|
    v_cvt_pk_bf16_f32 v156, |v136|, |v137|
    v_cvt_pk_bf16_f32 v157, |v138|, |v139|
    v_cvt_pk_bf16_f32 v158, |v140|, |v141|
    v_cvt_pk_bf16_f32 v159, |v142|, |v143|
    v_exp_f32 v242, v184
    v_exp_f32 v243, v185
    v_smfmac_f32_16x16x64_bf16 v[228:231], v[172:175], v[152:159], v250
    v_add_f32 v240, v240, v242
    v_fmac_f32 v241, v242, v186
    v_add_f32 v240, v240, v243
    v_fmac_f32 v241, v243, v187
    s_nop 3
    v_exp_f32 v244, v228
    v_exp_f32 v245, v229
    v_add_f32 v240, v240, v244
    v_fmac_f32 v241, v244, v230
    v_add_f32 v240, v240, v245
    v_fmac_f32 v241, v245, v231
    s_nop 0
    v_add_f32_dpp v240, v240, v240 row_shr:1 row_mask:0xf bank_mask:0xf
    v_add_f32_dpp v241, v241, v241 row_shr:1 row_mask:0xf bank_mask:0xf
    s_nop 0
    v_add_f32_dpp v240, v240, v240 row_shr:2 row_mask:0xf bank_mask:0xf
    v_add_f32_dpp v241, v241, v241 row_shr:2 row_mask:0xf bank_mask:0xf
    s_nop 0
    v_add_f32_dpp v240, v240, v240 row_shr:4 row_mask:0xf bank_mask:0xf
    v_add_f32_dpp v241, v241, v241 row_shr:4 row_mask:0xf bank_mask:0xf
    s_nop 0
    v_add_f32_dpp v240, v240, v240 row_shr:8 row_mask:0xf bank_mask:0xf
    v_add_f32_dpp v241, v241, v241 row_shr:8 row_mask:0xf bank_mask:0xf
    s_nop 0
    v_add_f32_dpp v240, v240, v240 row_bcast:15 row_mask:0xa bank_mask:0xf
    v_add_f32_dpp v241, v241, v241 row_bcast:15 row_mask:0xa bank_mask:0xf
    s_nop 0
    v_add_f32_dpp v240, v240, v240 row_bcast:31 row_mask:0xc bank_mask:0xf
    v_add_f32_dpp v241, v241, v241 row_bcast:31 row_mask:0xc bank_mask:0xf
    s_mov_b32 exec_lo, 0
    s_mov_b32 exec_hi, 0x80000000
    ds_wrxchg_rtn_b64 v[56:57], v252, v[240:241]
    s_lshl_b32 s3, s3, 1
    v_mov_b32 v65, s3
    s_waitcnt lgkmcnt(0)
    v_cmp_gt_f32 vcc, 0, v56
    v_add_f32 v240, v240, v56
    v_add_f32 v241, v241, v57
    s_cbranch_vccnz L_done
    v_fma_f32 v60, v241, 0, v240
    v_rcp_f32 v61, v240
    v_subrev_u32 v60, 0x21800000, v60
    v_cmp_lt_u32 vcc, 0x46000000, v60
    v_mul_f32 v62, v241, v61
    s_cbranch_vccnz L_slow
L_store:
    v_cvt_pk_bf16_f32 v62, v62, v62
    global_store_short v65, v62, s[16:17]
L_done:
    s_endpgm
L_role1:
    s_setprio 1
    s_waitcnt vmcnt(0)
    v_add_u32 v125, 93824, v122
    v_mov_b32 v254, 0
    s_movk_i32 s46, 148
    v_mul_u32_u24 v6, 354, v122
    v_lshrrev_b32 v7, 2, v253
    v_lshl_add_u32 v6, v7, 4, v6
    s_mul_i32 s31, s22, 768
    s_add_u32 s31, s31, s23
    v_add_u32 v255, s31, v6
    s_mul_i32 s30, s22, 576
    s_add_u32 s30, s30, s23
    s_sub_u32 s30, s30, 64
    v_mul_u32_u24 v142, 5664, v141
    v_and_b32 v143, 31, v253
    v_lshl_add_u32 v6, v143, 4, v142
    v_add_u32 v251, s23, v6
    v_add_u32 v6, 832, v6
    v_add_u32 v246, s30, v6
    v_bfe_u32 v6, v253, 1, 1
    v_lshl_add_u32 v7, v6, 4, v142
    v_add_u32 v7, 768, v7
    v_add_u32 v247, s30, v7
    v_mul_u32_u24 v6, 68, v6
    v_and_b32 v7, 1, v253
    v_lshl_add_u32 v6, v7, 1, v6
    v_bfe_u32 v7, v253, 3, 1
    v_add_u32 v6, s46, v6
    v_lshl_add_u32 v6, v6, 4, v142
    v_cmp_eq_u32 vcc, 0, v123
    v_add_u32 v249, s30, v6
    v_lshl_add_u32 v6, v7, 4, v249
    v_mul_u32_u24 v7, 0xaaaa, v7
    v_add_u32 v250, 0x4444, v7
    v_cndmask_b32 v248, v140, v6, vcc
    v_and_b32 v6, 4, v253
    v_lshl_add_u32 v249, v6, 2, v249
    v_and_b32 v6, 24, v253
    v_lshl_add_u32 v249, v6, 3, v249
    ds_read_b128 v[184:187], v125 offset:0
    ds_read_b128 v[188:191], v125 offset:64
    ds_read_b128 v[8:11], v134 offset:0
    ds_read_b128 v[12:15], v134 offset:32
    ds_read_b128 v[16:19], v134 offset:1280
    ds_read_b128 v[20:23], v134 offset:1312
    ds_read_b128 v[24:27], v137 offset:0
    ds_read_b128 v[28:31], v137 offset:16
    ds_read_b128 v[32:35], v137 offset:32
    ds_read_b128 v[36:39], v137 offset:48
    ds_read_b128 v[40:43], v137 offset:128
    ds_read_b128 v[44:47], v137 offset:144
    ds_read_b128 v[48:51], v137 offset:160
    ds_read_b128 v[52:55], v137 offset:176
    ds_read_b128 v[160:163], v135 offset:0
    ds_read_b128 v[168:171], v136 offset:0
    ds_read_b128 v[164:167], v135 offset:128
    ds_read_b128 v[172:175], v136 offset:128
    s_waitcnt lgkmcnt(0)
    v_lshl_or_b32 v112, v112, 6, v122
    buffer_load_dwordx4 v[200:203], v112, s[36:39], 0 offen
    v_lshl_or_b32 v113, v113, 6, v122
    buffer_load_dwordx4 v[204:207], v113, s[36:39], 0 offen
    v_lshl_or_b32 v114, v114, 6, v122
    buffer_load_dwordx4 v[208:211], v114, s[36:39], 0 offen
    v_lshl_or_b32 v115, v115, 6, v122
    buffer_load_dwordx4 v[212:215], v115, s[36:39], 0 offen
    s_mov_b64 exec, 0xffff
    v_lshl_or_b32 v116, v116, 6, v122
    buffer_load_dwordx4 v[216:219], v116, s[36:39], 0 offen
    s_mov_b64 exec, -1
    s_waitcnt vmcnt(4)
    v_lshlrev_b32 v6, 16, v200
    v_and_b32 v7, s43, v200
    v_cvt_pk_f16_f32 v200, v6, v7
    v_lshlrev_b32 v6, 16, v201
    v_and_b32 v7, s43, v201
    v_cvt_pk_f16_f32 v201, v6, v7
    v_lshlrev_b32 v6, 16, v202
    v_and_b32 v7, s43, v202
    v_cvt_pk_f16_f32 v202, v6, v7
    v_lshlrev_b32 v6, 16, v203
    v_and_b32 v7, s43, v203
    v_cvt_pk_f16_f32 v203, v6, v7
    ds_write_b128 v255, v[200:203] offset:0
    ds_write_b128 v255, v[200:203] offset:1088
    v_pk_mul_f16 v220, v200, v184
    v_pk_mul_f16 v221, v201, v185
    v_pk_mul_f16 v222, v202, v186
    v_pk_mul_f16 v223, v203, v187
    ds_write_b128 v255, v[220:223] offset:1600
    v_pk_mul_f16 v224, v200, v188
    v_pk_mul_f16 v225, v201, v189
    v_pk_mul_f16 v226, v202, v190
    v_pk_mul_f16 v227, v203, v191
    ds_write_b128 v255, v[224:227] offset:2688
    v_pk_maximum3_f16 v254, v200, v200, v254 neg_lo:[0,1,0] neg_hi:[0,1,0]
    v_pk_maximum3_f16 v254, v201, v201, v254 neg_lo:[0,1,0] neg_hi:[0,1,0]
    v_pk_maximum3_f16 v254, v202, v202, v254 neg_lo:[0,1,0] neg_hi:[0,1,0]
    v_pk_maximum3_f16 v254, v203, v203, v254 neg_lo:[0,1,0] neg_hi:[0,1,0]
    s_waitcnt vmcnt(3)
    v_lshlrev_b32 v6, 16, v204
    v_and_b32 v7, s43, v204
    v_cvt_pk_f16_f32 v204, v6, v7
    v_lshlrev_b32 v6, 16, v205
    v_and_b32 v7, s43, v205
    v_cvt_pk_f16_f32 v205, v6, v7
    v_lshlrev_b32 v6, 16, v206
    v_and_b32 v7, s43, v206
    v_cvt_pk_f16_f32 v206, v6, v7
    v_lshlrev_b32 v6, 16, v207
    v_and_b32 v7, s43, v207
    v_cvt_pk_f16_f32 v207, v6, v7
    ds_write_b128 v255, v[204:207] offset:256
    ds_write_b128 v255, v[204:207] offset:1344
    v_pk_mul_f16 v228, v204, v184
    v_pk_mul_f16 v229, v205, v185
    v_pk_mul_f16 v230, v206, v186
    v_pk_mul_f16 v231, v207, v187
    ds_write_b128 v255, v[228:231] offset:1856
    v_pk_mul_f16 v232, v204, v188
    v_pk_mul_f16 v233, v205, v189
    v_pk_mul_f16 v234, v206, v190
    v_pk_mul_f16 v235, v207, v191
    ds_write_b128 v255, v[232:235] offset:2944
    v_pk_maximum3_f16 v254, v204, v204, v254 neg_lo:[0,1,0] neg_hi:[0,1,0]
    v_pk_maximum3_f16 v254, v205, v205, v254 neg_lo:[0,1,0] neg_hi:[0,1,0]
    v_pk_maximum3_f16 v254, v206, v206, v254 neg_lo:[0,1,0] neg_hi:[0,1,0]
    v_pk_maximum3_f16 v254, v207, v207, v254 neg_lo:[0,1,0] neg_hi:[0,1,0]
    s_waitcnt vmcnt(2)
    v_lshlrev_b32 v6, 16, v208
    v_and_b32 v7, s43, v208
    v_cvt_pk_f16_f32 v208, v6, v7
    v_lshlrev_b32 v6, 16, v209
    v_and_b32 v7, s43, v209
    v_cvt_pk_f16_f32 v209, v6, v7
    v_lshlrev_b32 v6, 16, v210
    v_and_b32 v7, s43, v210
    v_cvt_pk_f16_f32 v210, v6, v7
    v_lshlrev_b32 v6, 16, v211
    v_and_b32 v7, s43, v211
    v_cvt_pk_f16_f32 v211, v6, v7
    ds_write_b128 v255, v[208:211] offset:512
    v_pk_mul_f16 v220, v208, v184
    v_pk_mul_f16 v221, v209, v185
    v_pk_mul_f16 v222, v210, v186
    v_pk_mul_f16 v223, v211, v187
    ds_write_b128 v255, v[220:223] offset:2112
    v_pk_mul_f16 v224, v208, v188
    v_pk_mul_f16 v225, v209, v189
    v_pk_mul_f16 v226, v210, v190
    v_pk_mul_f16 v227, v211, v191
    ds_write_b128 v255, v[224:227] offset:3200
    v_pk_maximum3_f16 v254, v208, v208, v254 neg_lo:[0,1,0] neg_hi:[0,1,0]
    v_pk_maximum3_f16 v254, v209, v209, v254 neg_lo:[0,1,0] neg_hi:[0,1,0]
    v_pk_maximum3_f16 v254, v210, v210, v254 neg_lo:[0,1,0] neg_hi:[0,1,0]
    v_pk_maximum3_f16 v254, v211, v211, v254 neg_lo:[0,1,0] neg_hi:[0,1,0]
    s_waitcnt vmcnt(1)
    v_lshlrev_b32 v6, 16, v212
    v_and_b32 v7, s43, v212
    v_cvt_pk_f16_f32 v212, v6, v7
    v_lshlrev_b32 v6, 16, v213
    v_and_b32 v7, s43, v213
    v_cvt_pk_f16_f32 v213, v6, v7
    v_lshlrev_b32 v6, 16, v214
    v_and_b32 v7, s43, v214
    v_cvt_pk_f16_f32 v214, v6, v7
    v_lshlrev_b32 v6, 16, v215
    v_and_b32 v7, s43, v215
    v_cvt_pk_f16_f32 v215, v6, v7
    ds_write_b128 v255, v[212:215] offset:768
    v_pk_mul_f16 v228, v212, v184
    v_pk_mul_f16 v229, v213, v185
    v_pk_mul_f16 v230, v214, v186
    v_pk_mul_f16 v231, v215, v187
    ds_write_b128 v255, v[228:231] offset:2368
    v_pk_mul_f16 v232, v212, v188
    v_pk_mul_f16 v233, v213, v189
    v_pk_mul_f16 v234, v214, v190
    v_pk_mul_f16 v235, v215, v191
    ds_write_b128 v255, v[232:235] offset:3456
    v_pk_maximum3_f16 v254, v212, v212, v254 neg_lo:[0,1,0] neg_hi:[0,1,0]
    v_pk_maximum3_f16 v254, v213, v213, v254 neg_lo:[0,1,0] neg_hi:[0,1,0]
    v_pk_maximum3_f16 v254, v214, v214, v254 neg_lo:[0,1,0] neg_hi:[0,1,0]
    v_pk_maximum3_f16 v254, v215, v215, v254 neg_lo:[0,1,0] neg_hi:[0,1,0]
    s_waitcnt vmcnt(0)
    s_mov_b64 exec, 0xffff
    v_lshlrev_b32 v6, 16, v216
    v_and_b32 v7, s43, v216
    v_cvt_pk_f16_f32 v216, v6, v7
    v_lshlrev_b32 v6, 16, v217
    v_and_b32 v7, s43, v217
    v_cvt_pk_f16_f32 v217, v6, v7
    v_lshlrev_b32 v6, 16, v218
    v_and_b32 v7, s43, v218
    v_cvt_pk_f16_f32 v218, v6, v7
    v_lshlrev_b32 v6, 16, v219
    v_and_b32 v7, s43, v219
    v_cvt_pk_f16_f32 v219, v6, v7
    ds_write_b128 v255, v[216:219] offset:1024
    v_pk_mul_f16 v220, v216, v184
    v_pk_mul_f16 v221, v217, v185
    v_pk_mul_f16 v222, v218, v186
    v_pk_mul_f16 v223, v219, v187
    ds_write_b128 v255, v[220:223] offset:2624
    v_pk_mul_f16 v224, v216, v188
    v_pk_mul_f16 v225, v217, v189
    v_pk_mul_f16 v226, v218, v190
    v_pk_mul_f16 v227, v219, v191
    ds_write_b128 v255, v[224:227] offset:3712
    v_pk_maximum3_f16 v254, v216, v216, v254 neg_lo:[0,1,0] neg_hi:[0,1,0]
    v_pk_maximum3_f16 v254, v217, v217, v254 neg_lo:[0,1,0] neg_hi:[0,1,0]
    v_pk_maximum3_f16 v254, v218, v218, v254 neg_lo:[0,1,0] neg_hi:[0,1,0]
    v_pk_maximum3_f16 v254, v219, v219, v254 neg_lo:[0,1,0] neg_hi:[0,1,0]
    s_mov_b64 exec, -1
    ds_write_b32 v252, v252 offset:12
    ds_read_b128 v[72:75], v247 offset:0
    ds_read_b128 v[76:79], v247 offset:11328
    ds_read_b128 v[80:83], v247 offset:32
    ds_read_b128 v[84:87], v247 offset:11360
    ds_read_b128 v[88:91], v246 offset:0
    ds_read_b128 v[92:95], v246 offset:11328
    ds_read_b128 v[176:179], v248 offset:0
    ds_read_b128 v[180:183], v248 offset:11328
    v_lshrrev_b32 v6, 16, v254
    v_and_b32 v7, 0xffff, v254
    v_max_u32 v6, v6, v7
    v_cmp_le_u32 vcc, 0x3000, v6
    v_mov_b32 v7, 0x7fc00000
    s_nop 0
    s_cmp_eq_u64 vcc, 0
    s_cselect_b32 s47, -1, 0x4800
    v_cmp_lt_i32 vcc, s47, v6
    s_nop 1
    v_cndmask_b32 v240, v240, v7, vcc
L_waitq:
    ds_read_b32 v254, v252 offset:8
    ds_read_b128 v[104:107], v251 offset:0
    ds_read_b128 v[108:111], v251 offset:11328
    s_waitcnt lgkmcnt(2)
    v_cmp_eq_u32 vcc, 0, v254
    s_cbranch_vccnz L_waitq
    v_pk_mul_f16 v56, v8, v72
    v_pk_mul_f16 v57, v9, v73
    v_pk_mul_f16 v58, v10, v74
    v_pk_mul_f16 v59, v11, v75
    v_pk_mul_f16 v60, v12, v76
    v_pk_mul_f16 v61, v13, v77
    v_pk_mul_f16 v62, v14, v78
    v_pk_mul_f16 v63, v15, v79
    s_setprio 1
    v_mfma_f32_32x32x16_f16 v[112:127], v[56:59], v[88:91], v[24:39]
    v_pk_mul_f16 v64, v8, v80
    v_pk_mul_f16 v65, v9, v81
    v_pk_mul_f16 v66, v10, v82
    v_pk_mul_f16 v67, v11, v83
    v_pk_mul_f16 v68, v12, v84
    v_mfma_f32_32x32x16_f16 v[112:127], v[60:63], v[92:95], v[112:127]
    s_waitcnt lgkmcnt(0)
    v_mfma_f32_32x32x16_f16 v[128:143], v[56:59], v[104:107], v[24:39]
    v_pk_mul_f16 v69, v13, v85
    v_pk_mul_f16 v70, v14, v86
    v_pk_mul_f16 v71, v15, v87
    ds_read_b128 v[96:99], v246 offset:64
    ds_read_b128 v[100:103], v246 offset:11392
    v_mfma_f32_32x32x16_f16 v[128:143], v[60:63], v[108:111], v[128:143]
    s_nop 3
    v_cvt_pk_bf16_f32 v144, |v112|, |v113|
    v_cvt_pk_bf16_f32 v145, |v114|, |v115|
    v_cvt_pk_bf16_f32 v146, |v116|, |v117|
    v_cvt_pk_bf16_f32 v147, |v118|, |v119|
    v_cvt_pk_bf16_f32 v148, |v120|, |v121|
    v_cvt_pk_bf16_f32 v149, |v122|, |v123|
    v_mfma_f32_16x16x32_f16 v[184:187], v[176:179], v[88:91], 0
    v_cvt_pk_bf16_f32 v150, |v124|, |v125|
    v_cvt_pk_bf16_f32 v151, |v126|, |v127|
    v_mfma_f32_16x16x32_f16 v[184:187], v[180:183], v[92:95], v[184:187]
    v_mfma_f32_16x16x32_f16 v[188:191], v[176:179], v[104:107], 0
    v_mfma_f32_16x16x32_f16 v[188:191], v[180:183], v[108:111], v[188:191]
    v_mfma_f32_32x32x16_f16 v[112:127], v[64:67], v[88:91], v[24:39]
    v_pk_mul_f16 v56, v16, v72
    v_pk_mul_f16 v57, v17, v73
    v_pk_mul_f16 v58, v18, v74
    v_pk_mul_f16 v59, v19, v75
    ds_read_b128 v[176:179], v248 offset:64
    ds_read_b128 v[180:183], v248 offset:11392
    v_mfma_f32_32x32x16_f16 v[112:127], v[68:71], v[92:95], v[112:127]
    v_cvt_pk_bf16_f32 v152, |v128|, |v129|
    v_cvt_pk_bf16_f32 v153, |v130|, |v131|
    v_cvt_pk_bf16_f32 v154, |v132|, |v133|
    v_cvt_pk_bf16_f32 v155, |v134|, |v135|
    v_cvt_pk_bf16_f32 v156, |v136|, |v137|
    v_cvt_pk_bf16_f32 v157, |v138|, |v139|
    v_smfmac_f32_16x16x64_bf16 v[184:187], v[160:163], v[144:151], v250
    v_cvt_pk_bf16_f32 v158, |v140|, |v141|
    v_cvt_pk_bf16_f32 v159, |v142|, |v143|
    v_mfma_f32_32x32x16_f16 v[128:143], v[64:67], v[104:107], v[24:39]
    v_pk_mul_f16 v60, v20, v76
    v_pk_mul_f16 v61, v21, v77
    v_pk_mul_f16 v62, v22, v78
    v_pk_mul_f16 v63, v23, v79
    ds_read_b128 v[232:235], v249 offset:64
    ds_read_b128 v[236:239], v249 offset:11392
    v_mfma_f32_32x32x16_f16 v[128:143], v[68:71], v[108:111], v[128:143]
    v_cvt_pk_bf16_f32 v144, |v112|, |v113|
    v_cvt_pk_bf16_f32 v145, |v114|, |v115|
    v_cvt_pk_bf16_f32 v146, |v116|, |v117|
    v_cvt_pk_bf16_f32 v147, |v118|, |v119|
    v_cvt_pk_bf16_f32 v148, |v120|, |v121|
    v_cvt_pk_bf16_f32 v149, |v122|, |v123|
    v_smfmac_f32_16x16x64_bf16 v[188:191], v[160:163], v[152:159], v250
    v_cvt_pk_bf16_f32 v150, |v124|, |v125|
    v_cvt_pk_bf16_f32 v151, |v126|, |v127|
    v_mfma_f32_32x32x16_f16 v[112:127], v[56:59], v[88:91], v[40:55]
    v_pk_mul_f16 v64, v16, v80
    v_pk_mul_f16 v65, v17, v81
    v_pk_mul_f16 v66, v18, v82
    ds_read_b128 v[72:75], v247 offset:64
    ds_read_b128 v[76:79], v247 offset:11392
    v_mfma_f32_32x32x16_f16 v[112:127], v[60:63], v[92:95], v[112:127]
    v_cvt_pk_bf16_f32 v152, |v128|, |v129|
    v_cvt_pk_bf16_f32 v153, |v130|, |v131|
    v_cvt_pk_bf16_f32 v154, |v132|, |v133|
    v_cvt_pk_bf16_f32 v155, |v134|, |v135|
    v_cvt_pk_bf16_f32 v156, |v136|, |v137|
    v_cvt_pk_bf16_f32 v157, |v138|, |v139|
    v_smfmac_f32_16x16x64_bf16 v[184:187], v[168:171], v[144:151], v250
    v_cvt_pk_bf16_f32 v158, |v140|, |v141|
    v_cvt_pk_bf16_f32 v159, |v142|, |v143|
    v_mfma_f32_32x32x16_f16 v[128:143], v[56:59], v[104:107], v[40:55]
    v_pk_mul_f16 v67, v19, v83
    v_pk_mul_f16 v68, v20, v84
    v_pk_mul_f16 v69, v21, v85
    v_pk_mul_f16 v70, v22, v86
    v_pk_mul_f16 v71, v23, v87
    v_cvt_pk_bf16_f32 v144, |v112|, |v113|
    v_mfma_f32_32x32x16_f16 v[128:143], v[60:63], v[108:111], v[128:143]
    v_cvt_pk_bf16_f32 v145, |v114|, |v115|
    v_cvt_pk_bf16_f32 v146, |v116|, |v117|
    v_cvt_pk_bf16_f32 v147, |v118|, |v119|
    v_cvt_pk_bf16_f32 v148, |v120|, |v121|
    v_cvt_pk_bf16_f32 v149, |v122|, |v123|
    v_cvt_pk_bf16_f32 v150, |v124|, |v125|
    v_smfmac_f32_16x16x64_bf16 v[188:191], v[168:171], v[152:159], v250
    v_cvt_pk_bf16_f32 v151, |v126|, |v127|
    s_waitcnt lgkmcnt(2)
    v_mfma_f32_32x32x16_f16 v[200:215], v[232:235], v[104:107], 0
    v_mfma_f32_32x32x16_f16 v[200:215], v[236:239], v[108:111], v[200:215]
    v_mfma_f32_32x32x16_f16 v[112:127], v[64:67], v[88:91], v[40:55]
    s_waitcnt lgkmcnt(0)
    v_pk_mul_f16 v56, v8, v72
    v_pk_mul_f16 v57, v9, v73
    v_pk_mul_f16 v58, v10, v74
    v_pk_mul_f16 v59, v11, v75
    ds_read_b128 v[80:83], v247 offset:96
    ds_read_b128 v[84:87], v247 offset:11424
    v_mfma_f32_32x32x16_f16 v[112:127], v[68:71], v[92:95], v[112:127]
    v_cvt_pk_bf16_f32 v152, |v128|, |v129|
    v_cvt_pk_bf16_f32 v153, |v130|, |v131|
    v_cvt_pk_bf16_f32 v154, |v132|, |v133|
    v_cvt_pk_bf16_f32 v155, |v134|, |v135|
    v_cvt_pk_bf16_f32 v156, |v136|, |v137|
    v_cvt_pk_bf16_f32 v157, |v138|, |v139|
    v_smfmac_f32_16x16x64_bf16 v[184:187], v[164:167], v[144:151], v250
    v_cvt_pk_bf16_f32 v158, |v140|, |v141|
    v_cvt_pk_bf16_f32 v159, |v142|, |v143|
    v_mfma_f32_32x32x16_f16 v[128:143], v[64:67], v[104:107], v[40:55]
    v_pk_mul_f16 v60, v12, v76
    v_pk_mul_f16 v61, v13, v77
    v_pk_mul_f16 v62, v14, v78
    v_pk_mul_f16 v63, v15, v79
    v_mfma_f32_32x32x16_f16 v[128:143], v[68:71], v[108:111], v[128:143]
    v_cvt_pk_bf16_f32 v144, |v112|, |v113|
    v_cvt_pk_bf16_f32 v145, |v114|, |v115|
    v_cvt_pk_bf16_f32 v146, |v116|, |v117|
    v_cvt_pk_bf16_f32 v147, |v118|, |v119|
    v_cvt_pk_bf16_f32 v148, |v120|, |v121|
    v_cvt_pk_bf16_f32 v149, |v122|, |v123|
    v_smfmac_f32_16x16x64_bf16 v[188:191], v[164:167], v[152:159], v250
    v_cvt_pk_bf16_f32 v150, |v124|, |v125|
    v_cvt_pk_bf16_f32 v151, |v126|, |v127|
    v_mfma_f32_32x32x16_f16 v[112:127], v[56:59], v[96:99], v[24:39]
    s_waitcnt lgkmcnt(0)
    v_pk_mul_f16 v64, v8, v80
    v_pk_mul_f16 v65, v9, v81
    v_pk_mul_f16 v66, v10, v82
    v_pk_mul_f16 v67, v11, v83
    v_pk_mul_f16 v68, v12, v84
    v_cvt_pk_bf16_f32 v152, |v128|, |v129|
    v_mfma_f32_32x32x16_f16 v[112:127], v[60:63], v[100:103], v[112:127]
    v_cvt_pk_bf16_f32 v153, |v130|, |v131|
    v_cvt_pk_bf16_f32 v154, |v132|, |v133|
    v_cvt_pk_bf16_f32 v155, |v134|, |v135|
    v_cvt_pk_bf16_f32 v156, |v136|, |v137|
    v_cvt_pk_bf16_f32 v157, |v138|, |v139|
    v_cvt_pk_bf16_f32 v158, |v140|, |v141|
    v_smfmac_f32_16x16x64_bf16 v[184:187], v[172:175], v[144:151], v250
    v_cvt_pk_bf16_f32 v159, |v142|, |v143|
    v_mfma_f32_32x32x16_f16 v[128:143], v[56:59], v[104:107], v[24:39]
    v_pk_mul_f16 v69, v13, v85
    v_pk_mul_f16 v70, v14, v86
    v_pk_mul_f16 v71, v15, v87
    v_cvt_pk_bf16_f32 v144, |v112|, |v113|
    v_cvt_pk_bf16_f32 v145, |v114|, |v115|
    v_cvt_pk_bf16_f32 v146, |v116|, |v117|
    ds_read_b128 v[88:91], v246 offset:128
    ds_read_b128 v[92:95], v246 offset:11456
    v_mfma_f32_32x32x16_f16 v[128:143], v[60:63], v[108:111], v[128:143]
    v_cvt_pk_bf16_f32 v147, |v118|, |v119|
    v_cvt_pk_bf16_f32 v148, |v120|, |v121|
    v_cvt_pk_bf16_f32 v149, |v122|, |v123|
    v_cvt_pk_bf16_f32 v150, |v124|, |v125|
    v_cvt_pk_bf16_f32 v151, |v126|, |v127|
    v_exp_f32 v242, v184
    v_mfma_f32_16x16x32_f16 v[192:195], v[176:179], v[96:99], 0
    v_exp_f32 v243, v185
    v_mfma_f32_16x16x32_f16 v[192:195], v[180:183], v[100:103], v[192:195]
    v_add_f32 v240, v240, v242
    v_smfmac_f32_16x16x64_bf16 v[188:191], v[172:175], v[152:159], v250
    v_mfma_f32_32x32x16_f16 v[112:127], v[64:67], v[96:99], v[24:39]
    v_pk_mul_f16 v56, v16, v72
    v_pk_mul_f16 v57, v17, v73
    v_pk_mul_f16 v58, v18, v74
    v_pk_mul_f16 v59, v19, v75
    v_cvt_pk_bf16_f32 v152, |v128|, |v129|
    v_cvt_pk_bf16_f32 v153, |v130|, |v131|
    ds_read_b128 v[176:179], v248 offset:128
    ds_read_b128 v[180:183], v248 offset:11456
    v_mfma_f32_32x32x16_f16 v[112:127], v[68:71], v[100:103], v[112:127]
    v_cvt_pk_bf16_f32 v154, |v132|, |v133|
    v_cvt_pk_bf16_f32 v155, |v134|, |v135|
    v_cvt_pk_bf16_f32 v156, |v136|, |v137|
    v_cvt_pk_bf16_f32 v157, |v138|, |v139|
    v_cvt_pk_bf16_f32 v158, |v140|, |v141|
    v_cvt_pk_bf16_f32 v159, |v142|, |v143|
    v_smfmac_f32_16x16x64_bf16 v[192:195], v[160:163], v[144:151], v250
    v_exp_f32 v244, v188
    v_mfma_f32_32x32x16_f16 v[128:143], v[64:67], v[104:107], v[24:39]
    v_pk_mul_f16 v60, v20, v76
    v_pk_mul_f16 v61, v21, v77
    v_pk_mul_f16 v62, v22, v78
    v_pk_mul_f16 v63, v23, v79
    v_add_f32 v240, v240, v244
    v_cvt_pk_bf16_f32 v144, |v112|, |v113|
    v_mfma_f32_32x32x16_f16 v[128:143], v[68:71], v[108:111], v[128:143]
    v_cvt_pk_bf16_f32 v145, |v114|, |v115|
    v_cvt_pk_bf16_f32 v146, |v116|, |v117|
    v_cvt_pk_bf16_f32 v147, |v118|, |v119|
    v_cvt_pk_bf16_f32 v148, |v120|, |v121|
    v_cvt_pk_bf16_f32 v149, |v122|, |v123|
    v_cvt_pk_bf16_f32 v150, |v124|, |v125|
    v_smfmac_f32_16x16x64_bf16 v[200:203], v[160:163], v[152:159], v250
    v_cvt_pk_bf16_f32 v151, |v126|, |v127|
    v_mfma_f32_32x32x16_f16 v[112:127], v[56:59], v[96:99], v[40:55]
    v_pk_mul_f16 v64, v16, v80
    v_pk_mul_f16 v65, v17, v81
    v_pk_mul_f16 v66, v18, v82
    v_exp_f32 v245, v189
    v_cvt_pk_bf16_f32 v152, |v128|, |v129|
    ds_read_b128 v[72:75], v247 offset:128
    ds_read_b128 v[76:79], v247 offset:11456
    v_mfma_f32_32x32x16_f16 v[112:127], v[60:63], v[100:103], v[112:127]
    v_cvt_pk_bf16_f32 v153, |v130|, |v131|
    v_cvt_pk_bf16_f32 v154, |v132|, |v133|
    v_cvt_pk_bf16_f32 v155, |v134|, |v135|
    v_cvt_pk_bf16_f32 v156, |v136|, |v137|
    v_cvt_pk_bf16_f32 v157, |v138|, |v139|
    v_cvt_pk_bf16_f32 v158, |v140|, |v141|
    v_smfmac_f32_16x16x64_bf16 v[192:195], v[168:171], v[144:151], v250
    v_cvt_pk_bf16_f32 v159, |v142|, |v143|
    v_fmac_f32 v241, v244, v190
    v_mfma_f32_32x32x16_f16 v[128:143], v[56:59], v[104:107], v[40:55]
    v_pk_mul_f16 v67, v19, v83
    v_pk_mul_f16 v68, v20, v84
    v_pk_mul_f16 v69, v21, v85
    v_pk_mul_f16 v70, v22, v86
    v_pk_mul_f16 v71, v23, v87
    v_cvt_pk_bf16_f32 v144, |v112|, |v113|
    v_mfma_f32_32x32x16_f16 v[128:143], v[60:63], v[108:111], v[128:143]
    v_cvt_pk_bf16_f32 v145, |v114|, |v115|
    v_cvt_pk_bf16_f32 v146, |v116|, |v117|
    v_cvt_pk_bf16_f32 v147, |v118|, |v119|
    v_cvt_pk_bf16_f32 v148, |v120|, |v121|
    v_cvt_pk_bf16_f32 v149, |v122|, |v123|
    v_cvt_pk_bf16_f32 v150, |v124|, |v125|
    v_smfmac_f32_16x16x64_bf16 v[200:203], v[168:171], v[152:159], v250
    v_cvt_pk_bf16_f32 v151, |v126|, |v127|
    v_add_f32 v240, v240, v245
    v_mfma_f32_32x32x16_f16 v[112:127], v[64:67], v[96:99], v[40:55]
    s_waitcnt lgkmcnt(0)
    v_pk_mul_f16 v56, v8, v72
    v_pk_mul_f16 v57, v9, v73
    v_pk_mul_f16 v58, v10, v74
    v_pk_mul_f16 v59, v11, v75
    v_fmac_f32 v241, v242, v186
    v_cvt_pk_bf16_f32 v152, |v128|, |v129|
    ds_read_b128 v[80:83], v247 offset:160
    ds_read_b128 v[84:87], v247 offset:11488
    v_mfma_f32_32x32x16_f16 v[112:127], v[68:71], v[100:103], v[112:127]
    v_cvt_pk_bf16_f32 v153, |v130|, |v131|
    v_cvt_pk_bf16_f32 v154, |v132|, |v133|
    v_cvt_pk_bf16_f32 v155, |v134|, |v135|
    v_cvt_pk_bf16_f32 v156, |v136|, |v137|
    v_cvt_pk_bf16_f32 v157, |v138|, |v139|
    v_cvt_pk_bf16_f32 v158, |v140|, |v141|
    v_smfmac_f32_16x16x64_bf16 v[192:195], v[164:167], v[144:151], v250
    v_cvt_pk_bf16_f32 v159, |v142|, |v143|
    v_fmac_f32 v241, v245, v191
    v_mfma_f32_32x32x16_f16 v[128:143], v[64:67], v[104:107], v[40:55]
    v_pk_mul_f16 v60, v12, v76
    v_pk_mul_f16 v61, v13, v77
    v_pk_mul_f16 v62, v14, v78
    v_pk_mul_f16 v63, v15, v79
    v_add_f32 v240, v240, v243
    v_cvt_pk_bf16_f32 v144, |v112|, |v113|
    v_mfma_f32_32x32x16_f16 v[128:143], v[68:71], v[108:111], v[128:143]
    v_cvt_pk_bf16_f32 v145, |v114|, |v115|
    v_cvt_pk_bf16_f32 v146, |v116|, |v117|
    v_cvt_pk_bf16_f32 v147, |v118|, |v119|
    v_cvt_pk_bf16_f32 v148, |v120|, |v121|
    v_cvt_pk_bf16_f32 v149, |v122|, |v123|
    v_cvt_pk_bf16_f32 v150, |v124|, |v125|
    v_smfmac_f32_16x16x64_bf16 v[200:203], v[164:167], v[152:159], v250
    v_cvt_pk_bf16_f32 v151, |v126|, |v127|
    v_fmac_f32 v241, v243, v187
    s_branch L_mid1
L_end:
    s_endpgm
L_slow:
    s_mov_b64 exec, -1
    s_load_dwordx2 s[48:49], s[0:1], 16
    s_load_dwordx2 s[52:53], s[0:1], 24
    s_load_dwordx16 s[64:79], s[10:11], 0
    s_load_dwordx16 s[80:95], s[12:13], 0
    s_movk_i32 s50, 19800
    s_mov_b32 s51, 0x00020000
    s_movk_i32 s54, 19800
    s_mov_b32 s55, 0x00020000
    s_mul_i32 s30, s3, 200
    v_lshrrev_b32 v8, 2, v253
    v_and_b32 v9, 3, v253
    v_lshlrev_b32 v9, 4, v9
    v_mul_u32_u24 v10, 80, v8
    v_add3_u32 v10, v10, v9, s23
    v_lshlrev_b32 v8, 2, v8
    v_add_u32 v8, s30, v8
    global_load_dwordx4 v[12:15], v9, s[14:15]
    v_add_u32 v11, s23, v9
    s_waitcnt vmcnt(0)
    ds_write_b128 v11, v[12:15] offset:8960
    s_mov_b32 s24, 7
L_sl_rows:
    buffer_load_dword v11, v8, s[4:7], 0 offen
    s_waitcnt vmcnt(0)
    v_lshl_or_b32 v11, v11, 6, v9
    buffer_load_dwordx4 v[16:19], v11, s[36:39], 0 offen
    s_waitcnt vmcnt(0)
    ds_write_b128 v10, v[16:19]
    v_add_u32 v8, 64, v8
    v_add_u32 v10, 1280, v10
    s_waitcnt lgkmcnt(0)
    s_sub_u32 s24, s24, 1
    s_cmp_lg_u32 s24, 0
    s_cbranch_scc1 L_sl_rows
    v_mov_b32 v24, 0xff7fffff
    v_mov_b32 v25, 0
    v_mov_b32 v26, 0
    v_lshlrev_b32 v31, 2, v253
    v_mov_b32 v8, 0
    v_mov_b32 v9, 0
    v_mov_b32 v10, 0
    s_mov_b32 s24, 78
L_sl_chunk:
    buffer_load_dword v28, v31, s[48:51], 0 offen
    buffer_load_dword v29, v31, s[52:55], 0 offen
    v_mov_b32 v27, 0
    v_mov_b32 v30, s23
    s_lshl_b32 s44, s64, 16
    s_and_b32 s45, s64, s43
    v_mov_b32 v112, s44
    v_mov_b32 v113, s45
    s_lshl_b32 s44, s65, 16
    s_and_b32 s45, s65, s43
    v_mov_b32 v114, s44
    v_mov_b32 v115, s45
    s_lshl_b32 s44, s66, 16
    s_and_b32 s45, s66, s43
    v_mov_b32 v116, s44
    v_mov_b32 v117, s45
    s_lshl_b32 s44, s67, 16
    s_and_b32 s45, s67, s43
    v_mov_b32 v118, s44
    v_mov_b32 v119, s45
    s_lshl_b32 s44, s68, 16
    s_and_b32 s45, s68, s43
    v_mov_b32 v120, s44
    v_mov_b32 v121, s45
    s_lshl_b32 s44, s69, 16
    s_and_b32 s45, s69, s43
    v_mov_b32 v122, s44
    v_mov_b32 v123, s45
    s_lshl_b32 s44, s70, 16
    s_and_b32 s45, s70, s43
    v_mov_b32 v124, s44
    v_mov_b32 v125, s45
    s_lshl_b32 s44, s71, 16
    s_and_b32 s45, s71, s43
    v_mov_b32 v126, s44
    v_mov_b32 v127, s45
    s_lshl_b32 s44, s72, 16
    s_and_b32 s45, s72, s43
    v_mov_b32 v128, s44
    v_mov_b32 v129, s45
    s_lshl_b32 s44, s73, 16
    s_and_b32 s45, s73, s43
    v_mov_b32 v130, s44
    v_mov_b32 v131, s45
    s_lshl_b32 s44, s74, 16
    s_and_b32 s45, s74, s43
    v_mov_b32 v132, s44
    v_mov_b32 v133, s45
    s_lshl_b32 s44, s75, 16
    s_and_b32 s45, s75, s43
    v_mov_b32 v134, s44
    v_mov_b32 v135, s45
    s_lshl_b32 s44, s76, 16
    s_and_b32 s45, s76, s43
    v_mov_b32 v136, s44
    v_mov_b32 v137, s45
    s_lshl_b32 s44, s77, 16
    s_and_b32 s45, s77, s43
    v_mov_b32 v138, s44
    v_mov_b32 v139, s45
    s_lshl_b32 s44, s78, 16
    s_and_b32 s45, s78, s43
    v_mov_b32 v140, s44
    v_mov_b32 v141, s45
    s_lshl_b32 s44, s79, 16
    s_and_b32 s45, s79, s43
    v_mov_b32 v142, s44
    v_mov_b32 v143, s45
    s_waitcnt vmcnt(0)
    v_min_u32 v28, 99, v28
    v_min_u32 v29, 99, v29
    v_mul_u32_u24 v28, 80, v28
    v_mul_u32_u24 v29, 80, v29
    v_add_u32 v28, s23, v28
    v_add_u32 v29, s23, v29
    s_mov_b32 s46, 0
L_sl_d:
    s_load_dwordx8 s[56:63], s[8:9], s46
    s_add_u32 s47, s46, 32
    s_load_dwordx4 s[96:99], s[8:9], s47
    s_add_u32 s47, s46, 48
    s_load_dwordx4 s[32:35], s[8:9], s47
    ds_read_u16_d16_hi v8, v28
    ds_read_u16_d16_hi v9, v29
    ds_read_u16_d16_hi v10, v30 offset:8960
    v_add_u32 v28, 2, v28
    v_add_u32 v29, 2, v29
    v_add_u32 v30, 2, v30
    s_waitcnt lgkmcnt(0)
    v_mul_f32 v11, v8, v9
    v_fmac_f32 v27, v11, v10
    s_lshl_b32 s44, s56, 16
    s_and_b32 s45, s56, s43
    v_fmac_f32 v112, s44, v11
    v_fmac_f32 v113, s45, v11
    s_lshl_b32 s44, s57, 16
    s_and_b32 s45, s57, s43
    v_fmac_f32 v114, s44, v11
    v_fmac_f32 v115, s45, v11
    s_lshl_b32 s44, s58, 16
    s_and_b32 s45, s58, s43
    v_fmac_f32 v116, s44, v11
    v_fmac_f32 v117, s45, v11
    s_lshl_b32 s44, s59, 16
    s_and_b32 s45, s59, s43
    v_fmac_f32 v118, s44, v11
    v_fmac_f32 v119, s45, v11
    s_lshl_b32 s44, s60, 16
    s_and_b32 s45, s60, s43
    v_fmac_f32 v120, s44, v11
    v_fmac_f32 v121, s45, v11
    s_lshl_b32 s44, s61, 16
    s_and_b32 s45, s61, s43
    v_fmac_f32 v122, s44, v11
    v_fmac_f32 v123, s45, v11
    s_lshl_b32 s44, s62, 16
    s_and_b32 s45, s62, s43
    v_fmac_f32 v124, s44, v11
    v_fmac_f32 v125, s45, v11
    s_lshl_b32 s44, s63, 16
    s_and_b32 s45, s63, s43
    v_fmac_f32 v126, s44, v11
    v_fmac_f32 v127, s45, v11
    s_lshl_b32 s44, s96, 16
    s_and_b32 s45, s96, s43
    v_fmac_f32 v128, s44, v11
    v_fmac_f32 v129, s45, v11
    s_lshl_b32 s44, s97, 16
    s_and_b32 s45, s97, s43
    v_fmac_f32 v130, s44, v11
    v_fmac_f32 v131, s45, v11
    s_lshl_b32 s44, s98, 16
    s_and_b32 s45, s98, s43
    v_fmac_f32 v132, s44, v11
    v_fmac_f32 v133, s45, v11
    s_lshl_b32 s44, s99, 16
    s_and_b32 s45, s99, s43
    v_fmac_f32 v134, s44, v11
    v_fmac_f32 v135, s45, v11
    s_lshl_b32 s44, s32, 16
    s_and_b32 s45, s32, s43
    v_fmac_f32 v136, s44, v11
    v_fmac_f32 v137, s45, v11
    s_lshl_b32 s44, s33, 16
    s_and_b32 s45, s33, s43
    v_fmac_f32 v138, s44, v11
    v_fmac_f32 v139, s45, v11
    s_lshl_b32 s44, s34, 16
    s_and_b32 s45, s34, s43
    v_fmac_f32 v140, s44, v11
    v_fmac_f32 v141, s45, v11
    s_lshl_b32 s44, s35, 16
    s_and_b32 s45, s35, s43
    v_fmac_f32 v142, s44, v11
    v_fmac_f32 v143, s45, v11
    s_add_u32 s46, s46, 64
    s_cmp_lt_u32 s46, 2048
    s_cbranch_scc1 L_sl_d
    v_mov_b32 v12, 0
    s_lshl_b32 s44, s80, 16
    s_and_b32 s45, s80, s43
    v_max_f32 v112, 0, v112
    v_max_f32 v113, 0, v113
    v_fmac_f32 v12, s44, v112
    v_fmac_f32 v12, s45, v113
    s_lshl_b32 s44, s81, 16
    s_and_b32 s45, s81, s43
    v_max_f32 v114, 0, v114
    v_max_f32 v115, 0, v115
    v_fmac_f32 v12, s44, v114
    v_fmac_f32 v12, s45, v115
    s_lshl_b32 s44, s82, 16
    s_and_b32 s45, s82, s43
    v_max_f32 v116, 0, v116
    v_max_f32 v117, 0, v117
    v_fmac_f32 v12, s44, v116
    v_fmac_f32 v12, s45, v117
    s_lshl_b32 s44, s83, 16
    s_and_b32 s45, s83, s43
    v_max_f32 v118, 0, v118
    v_max_f32 v119, 0, v119
    v_fmac_f32 v12, s44, v118
    v_fmac_f32 v12, s45, v119
    s_lshl_b32 s44, s84, 16
    s_and_b32 s45, s84, s43
    v_max_f32 v120, 0, v120
    v_max_f32 v121, 0, v121
    v_fmac_f32 v12, s44, v120
    v_fmac_f32 v12, s45, v121
    s_lshl_b32 s44, s85, 16
    s_and_b32 s45, s85, s43
    v_max_f32 v122, 0, v122
    v_max_f32 v123, 0, v123
    v_fmac_f32 v12, s44, v122
    v_fmac_f32 v12, s45, v123
    s_lshl_b32 s44, s86, 16
    s_and_b32 s45, s86, s43
    v_max_f32 v124, 0, v124
    v_max_f32 v125, 0, v125
    v_fmac_f32 v12, s44, v124
    v_fmac_f32 v12, s45, v125
    s_lshl_b32 s44, s87, 16
    s_and_b32 s45, s87, s43
    v_max_f32 v126, 0, v126
    v_max_f32 v127, 0, v127
    v_fmac_f32 v12, s44, v126
    v_fmac_f32 v12, s45, v127
    s_lshl_b32 s44, s88, 16
    s_and_b32 s45, s88, s43
    v_max_f32 v128, 0, v128
    v_max_f32 v129, 0, v129
    v_fmac_f32 v12, s44, v128
    v_fmac_f32 v12, s45, v129
    s_lshl_b32 s44, s89, 16
    s_and_b32 s45, s89, s43
    v_max_f32 v130, 0, v130
    v_max_f32 v131, 0, v131
    v_fmac_f32 v12, s44, v130
    v_fmac_f32 v12, s45, v131
    s_lshl_b32 s44, s90, 16
    s_and_b32 s45, s90, s43
    v_max_f32 v132, 0, v132
    v_max_f32 v133, 0, v133
    v_fmac_f32 v12, s44, v132
    v_fmac_f32 v12, s45, v133
    s_lshl_b32 s44, s91, 16
    s_and_b32 s45, s91, s43
    v_max_f32 v134, 0, v134
    v_max_f32 v135, 0, v135
    v_fmac_f32 v12, s44, v134
    v_fmac_f32 v12, s45, v135
    s_lshl_b32 s44, s92, 16
    s_and_b32 s45, s92, s43
    v_max_f32 v136, 0, v136
    v_max_f32 v137, 0, v137
    v_fmac_f32 v12, s44, v136
    v_fmac_f32 v12, s45, v137
    s_lshl_b32 s44, s93, 16
    s_and_b32 s45, s93, s43
    v_max_f32 v138, 0, v138
    v_max_f32 v139, 0, v139
    v_fmac_f32 v12, s44, v138
    v_fmac_f32 v12, s45, v139
    s_lshl_b32 s44, s94, 16
    s_and_b32 s45, s94, s43
    v_max_f32 v140, 0, v140
    v_max_f32 v141, 0, v141
    v_fmac_f32 v12, s44, v140
    v_fmac_f32 v12, s45, v141
    s_lshl_b32 s44, s95, 16
    s_and_b32 s45, s95, s43
    v_max_f32 v142, 0, v142
    v_max_f32 v143, 0, v143
    v_fmac_f32 v12, s44, v142
    v_fmac_f32 v12, s45, v143
    v_cmp_gt_u32 vcc, 19800, v31
    s_and_b64 exec, exec, vcc
    v_max_f32 v13, v24, v12
    v_sub_f32 v14, v24, v13
    v_sub_f32 v15, v12, v13
    v_mul_f32 v14, 0x3fb8aa3b, v14
    v_mul_f32 v15, 0x3fb8aa3b, v15
    v_exp_f32 v14, v14
    v_exp_f32 v15, v15
    v_mov_b32 v24, v13
    v_fma_f32 v25, v25, v14, v15
    v_mul_f32 v26, v26, v14
    v_fmac_f32 v26, v15, v27
    s_mov_b64 exec, -1
    v_add_u32 v31, 256, v31
    s_sub_u32 s24, s24, 1
    s_cmp_lg_u32 s24, 0
    s_cbranch_scc1 L_sl_chunk
    v_mov_b32 v13, v24
    s_nop 1
    v_max_f32_dpp v13, v13, v13 row_shr:1 row_mask:0xf bank_mask:0xf
    s_nop 1
    v_max_f32_dpp v13, v13, v13 row_shr:2 row_mask:0xf bank_mask:0xf
    s_nop 1
    v_max_f32_dpp v13, v13, v13 row_shr:4 row_mask:0xf bank_mask:0xf
    s_nop 1
    v_max_f32_dpp v13, v13, v13 row_shr:8 row_mask:0xf bank_mask:0xf
    s_nop 1
    v_max_f32_dpp v13, v13, v13 row_bcast:15 row_mask:0xa bank_mask:0xf
    s_nop 1
    v_max_f32_dpp v13, v13, v13 row_bcast:31 row_mask:0xc bank_mask:0xf
    s_nop 0
    v_readlane_b32 s44, v13, 63
    s_nop 1
    v_subrev_f32 v14, s44, v24
    v_mul_f32 v14, 0x3fb8aa3b, v14
    v_exp_f32 v14, v14
    s_nop 0
    v_mul_f32 v25, v25, v14
    v_mul_f32 v26, v26, v14
    s_nop 1
    v_add_f32_dpp v25, v25, v25 row_shr:1 row_mask:0xf bank_mask:0xf
    v_add_f32_dpp v26, v26, v26 row_shr:1 row_mask:0xf bank_mask:0xf
    s_nop 1
    v_add_f32_dpp v25, v25, v25 row_shr:2 row_mask:0xf bank_mask:0xf
    v_add_f32_dpp v26, v26, v26 row_shr:2 row_mask:0xf bank_mask:0xf
    s_nop 1
    v_add_f32_dpp v25, v25, v25 row_shr:4 row_mask:0xf bank_mask:0xf
    v_add_f32_dpp v26, v26, v26 row_shr:4 row_mask:0xf bank_mask:0xf
    s_nop 1
    v_add_f32_dpp v25, v25, v25 row_shr:8 row_mask:0xf bank_mask:0xf
    v_add_f32_dpp v26, v26, v26 row_shr:8 row_mask:0xf bank_mask:0xf
    s_nop 1
    v_add_f32_dpp v25, v25, v25 row_bcast:15 row_mask:0xa bank_mask:0xf
    v_add_f32_dpp v26, v26, v26 row_bcast:15 row_mask:0xa bank_mask:0xf
    s_nop 1
    v_add_f32_dpp v25, v25, v25 row_bcast:31 row_mask:0xc bank_mask:0xf
    v_add_f32_dpp v26, v26, v26 row_bcast:31 row_mask:0xc bank_mask:0xf
    v_rcp_f32 v25, v25
    s_mov_b32 exec_lo, 0
    s_mov_b32 exec_hi, 0x80000000
    v_mul_f32 v62, v26, v25
    s_branch L_store
.section .rodata,"a"
.p2align 6
.amdhsa_kernel standalone__factorization_afm__recsys_kernel
  .amdhsa_next_free_vgpr 256
  .amdhsa_next_free_sgpr 102
  .amdhsa_accum_offset 256
  .amdhsa_group_segment_fixed_size 0
  .amdhsa_kernarg_size 88
  .amdhsa_user_sgpr_count 2
  .amdhsa_user_sgpr_kernarg_segment_ptr 1
  .amdhsa_system_sgpr_workgroup_id_x 1
.end_amdhsa_kernel
```
